```python
import torch

def _softmax(x, axis=-1):
    return torch.softmax(x, dim=axis)
def _gelu(x):
    return torch.nn.functional.gelu(x, approximate="tanh")
def _silu(x):
    return torch.nn.functional.silu(x)
def _sigmoid(x):
    return torch.sigmoid(x)
def _layernorm(x, axis=-1, eps=1e-5):
    m = x.mean(dim=axis, keepdim=True)
    v = x.var(dim=axis, keepdim=True, unbiased=False)
    return (x - m) / torch.sqrt(v + eps)
def _scatter_add(tgt, idx, src, axis=0):
    return tgt.clone().index_add_(axis, idx, src)
def _segment_sum(src, seg, n):
    out = torch.zeros((n,) + src.shape[1:], dtype=src.dtype)
    return out.index_add_(0, seg, src)
def _pad(x, pw):
    flat = tuple(v for pair in reversed(pw) for v in pair)
    return torch.nn.functional.pad(x, flat)

kernel_name = 'recurrent_scan__sliding_block_cached__geglu_ffn__decode'

def setup_inputs():

    _w = (lambda a: (lambda t: t.to(torch.bfloat16) if t.is_floating_point() else t)(torch.as_tensor(a)))
    def _A_setup():
        B, Sq, D = 1, 1, 1024
        Hq, Hkv, Sk, Dh = 32, 4, 65536, 128
        assert Hq % Hkv == 0, (Hq, Hkv)
        return {
            "x": _w((lambda *s: torch.randn(*s, dtype=torch.bfloat16) * 0.05)(B, Sq, D)),
            "k_cache": _w((lambda *s: torch.randn(*s, dtype=torch.bfloat16) * 1.6)(B, Hkv, Sk, Dh)),
            "v_cache": _w((lambda *s: torch.randn(*s, dtype=torch.bfloat16) * 0.2)(B, Hkv, Sk, Dh)),
            "wq": _w((lambda *s: torch.randn(*s, dtype=torch.bfloat16) * 1.6)(D, Hq * Dh) * (D ** -0.5)),
            "wo": _w((lambda *s: torch.randn(*s, dtype=torch.bfloat16) * 0.2)(Hq * Dh, D) * ((Hq * Dh) ** -0.5)),
        }
    _A_in = _A_setup()

    def _B_setup():
        B, S, D, F = 1, 1, 1024, 3584
        return {
            "x": _w((lambda *s: torch.randn(*s, dtype=torch.bfloat16) * 0.05)(B, S, D)),
            "w_gate": _w((lambda *s: torch.randn(*s, dtype=torch.bfloat16) * 0.1)(D, F)),
            "w_up": _w((lambda *s: torch.randn(*s, dtype=torch.bfloat16) * 0.1)(D, F)),
            "w_down": _w((lambda *s: torch.randn(*s, dtype=torch.bfloat16) * 0.1)(F, D)),
        }
    _B_in = _B_setup()

    return {
        "A_x": _A_in["x"],
        "A_k_cache": _A_in["k_cache"],
        "A_v_cache": _A_in["v_cache"],
        "A_wq": _A_in["wq"],
        "A_wo": _A_in["wo"],
        "B_x": _B_in["x"],
        "B_w_gate": _B_in["w_gate"],
        "B_w_up": _B_in["w_up"],
        "B_w_down": _B_in["w_down"],
    }

def reference(A_x, A_k_cache, A_v_cache, A_wq, A_wo, B_x, B_w_gate, B_w_up, B_w_down):
    def _A_ref(x, k_cache, v_cache, wq, wo):
        B, Sq, D = x.shape
        Hq, Dh = 32, 128
        Hkv, Sk = k_cache.shape[1], k_cache.shape[2]
        W = min(4096, max(256, Sk // 4))
        rep = Hq // Hkv
        q = (lambda x, *d: x.permute(*d))((x @ wq).reshape(B, Sq, Hq, Dh), 0, 2, 1, 3)
        k = (lambda x, n, axis: torch.repeat_interleave(x, n, dim=axis))(k_cache[:, :, Sk - W:, :], rep, axis=1)
        v = (lambda x, n, axis: torch.repeat_interleave(x, n, dim=axis))(v_cache[:, :, Sk - W:, :], rep, axis=1)
        scores = torch.einsum("bhqd,bhkd->bhqk", q, k) * (Dh ** -0.5)
        p = _softmax(scores, axis=-1)
        o = torch.einsum("bhqk,bhkd->bhqd", p, v)
        return (lambda x, *d: x.permute(*d))(o, 0, 2, 1, 3).reshape(B, Sq, Hq * Dh) @ wo

    def _B_ref(x, w_gate, w_up, w_down):
        return (_gelu(x @ w_gate) * (x @ w_up)) @ w_down

    x = A_x
    xn = _layernorm(x, axis=-1)
    s = _A_ref(xn, A_k_cache, A_v_cache, A_wq, A_wo)
    g = _silu(_B_ref(xn, B_w_gate, B_w_up, B_w_down))
    return x + s * g
```

```asm
; @launch grid=(256,1,1) block=(320,1,1) lds=98304
.amdgcn_target "amdgcn-amd-amdhsa--gfx950"
.text
.globl recurrent_scan__sliding_block_cached__geglu_ffn__decode_kernel
.p2align 8
.type recurrent_scan__sliding_block_cached__geglu_ffn__decode_kernel,@function
recurrent_scan__sliding_block_cached__geglu_ffn__decode_kernel:
    s_load_dwordx16 s[4:19], s[0:1], 0
    v_readfirstlane_b32 s3, v0
    v_subrev_u32 v1, 64, v0
    s_mov_b32 s31, 0x20000
    v_and_b32 v5, 7, v0
    s_lshr_b32 s3, s3, 6
    v_lshrrev_b32 v1, 3, v1
    s_cmp_lt_u32 s2, 128
    s_cbranch_scc0 L_G0
    s_sub_u32 s3, s3, 1
    s_cbranch_scc0 L_QA
L_C0:
    s_setprio 3
    v_lshlrev_b32 v11, 5, v0
    s_movk_i32 s34, 0x800
    s_mov_b32 s35, 0x20000
    s_waitcnt lgkmcnt(0)
    s_mov_b64 s[32:33], s[4:5]
    buffer_load_dwordx4 v[16:19], v11, s[32:35], 0 offen
    buffer_load_dwordx4 v[20:23], v11, s[32:35], 0 offen offset:16
    s_load_dwordx8 s[20:27], s[0:1], 64
    s_branch L_COMM
L_QA:
    v_lshlrev_b32 v2, 17, v1
    v_lshl_add_u32 v2, v5, 4, v2
    s_add_u32 s54, s2, 2
    s_and_b32 s54, s54, 63
    s_lshl_b32 s54, s54, 7
    s_lshr_b32 s55, s2, 6
    s_lshl_b32 s48, s55, 22
    s_add_u32 s48, s48, s54
    s_mov_b32 s30, 8388608
    s_waitcnt lgkmcnt(0)
    s_mov_b64 s[28:29], s[10:11]
    buffer_load_dwordx4 v[128:131], v2, s[28:31], s48 offen nt
    s_addk_i32 s48, 8192
    buffer_load_dwordx4 v[132:135], v2, s[28:31], s48 offen nt
    s_addk_i32 s48, 8192
    buffer_load_dwordx4 v[136:139], v2, s[28:31], s48 offen nt
    s_addk_i32 s48, 8192
    buffer_load_dwordx4 v[140:143], v2, s[28:31], s48 offen nt
    s_addk_i32 s48, 8192
    buffer_load_dwordx4 v[144:147], v2, s[28:31], s48 offen nt
    s_addk_i32 s48, 8192
    buffer_load_dwordx4 v[148:151], v2, s[28:31], s48 offen nt
    s_addk_i32 s48, 8192
    buffer_load_dwordx4 v[152:155], v2, s[28:31], s48 offen nt
    s_addk_i32 s48, 8192
    buffer_load_dwordx4 v[156:159], v2, s[28:31], s48 offen nt
    s_addk_i32 s48, 8192
    s_load_dwordx8 s[20:27], s[0:1], 64
    s_branch L_QA1
L_G0:
    s_cmp_ge_u32 s2, 256
    s_cbranch_scc1 L_end
    s_sub_u32 s3, s3, 1
    s_cbranch_scc0 L_G1
    s_branch L_C0
L_G1:
    s_sub_u32 s50, s2, 128
    s_mul_i32 s51, s50, 147
    s_lshr_b32 s51, s51, 10
    s_add_u32 s50, s50, s51
    s_and_b32 s51, s50, 7
    s_cmp_ge_u32 s51, 3
    s_addc_u32 s45, s50, 0
    s_bfe_u32 s50, s2, 0x40001
    s_lshl_b32 s51, s50, 3
    s_add_u32 s51, s51, 3
    s_add_u32 s99, s50, 96
    s_cmp_lt_u32 s50, 14
    s_cselect_b32 s51, s51, s99
    s_cmp_lt_u32 s2, 224
    s_cselect_b32 s45, s45, s51
    s_cselect_b32 s99, 0, 1
    s_and_b32 s99, s99, s2
    s_cmp_ge_u32 s45, 56
    s_cselect_b32 s98, 1, 0
    s_cselect_b32 s51, 56, 0
    s_sub_u32 s45, s45, s51
    s_cmp_lt_u32 s2, 224
    s_cselect_b32 s51, 1, 0
    s_lshl_b32 s51, 114688, s51
    v_mul_lo_u32 v2, v1, s51
    v_lshl_add_u32 v2, v5, 4, v2
    s_mul_i32 s48, s99, 3670016
    s_lshl_b32 s50, s45, 7
    s_add_u32 s48, s48, s50
    s_mov_b32 s30, 7340032
    s_cmp_eq_u32 s98, 0
    s_waitcnt lgkmcnt(0)
    s_cselect_b64 s[28:29], s[16:17], s[18:19]
    buffer_load_dwordx4 v[128:131], v2, s[28:31], s48 offen nt
    s_addk_i32 s48, 7168
    buffer_load_dwordx4 v[132:135], v2, s[28:31], s48 offen nt
    s_addk_i32 s48, 7168
    s_load_dwordx8 s[20:27], s[0:1], 64
    s_branch L_G
L_QA1:
    v_and_b32 v0, 63, v0
    v_lshrrev_b32 v4, 3, v0
    s_lshl_b32 s55, s55, 2
    s_add_u32 s55, s55, s3
    s_lshl_b32 s55, s55, 8
    s_add_u32 s55, s55, 74240
    v_lshl_add_u32 v60, v4, 5, s55
    v_and_b32 v6, 1, v5
    v_cmp_eq_u32 vcc, 1, v6
    v_mov_b32 v6, 0x0c0c0100
    v_mov_b32 v7, 0x01000c0c
    v_cndmask_b32 v6, v6, v7, vcc
    v_lshrrev_b32 v1, 1, v5
    v_mov_b32 v16, 0x0c0c0c0c
    v_xor_b32 v7, v6, v16
    v_lshrrev_b32 v7, 2, v7
    v_and_b32 v7, 0x02020202, v7
    v_or_b32 v7, v7, v6
    v_cmp_eq_u32 vcc, 0, v1
    s_nop 1
    v_cndmask_b32 v8, v16, v6, vcc
    v_cndmask_b32 v12, v16, v7, vcc
    v_cmp_eq_u32 vcc, 1, v1
    s_nop 1
    v_cndmask_b32 v9, v16, v6, vcc
    v_cndmask_b32 v13, v16, v7, vcc
    v_cmp_eq_u32 vcc, 2, v1
    s_nop 1
    v_cndmask_b32 v10, v16, v6, vcc
    v_cndmask_b32 v14, v16, v7, vcc
    v_cmp_eq_u32 vcc, 3, v1
    s_nop 1
    v_cndmask_b32 v11, v16, v6, vcc
    v_cndmask_b32 v15, v16, v7, vcc
    s_waitcnt lgkmcnt(0)
    s_load_dword s47, s[26:27], 0
    s_mov_b64 s[40:41], s[26:27]
    v_lshrrev_b32 v52, 4, v0
    v_and_b32 v53, 15, v0
    v_lshlrev_b32 v6, 8, v52
    s_bfe_u32 s54, s2, 0x20001
    s_and_b32 s55, s2, 1
    s_lshl_b32 s55, s55, 4
    s_lshr_b32 s50, s2, 3
    s_add_u32 s55, s55, s50
    s_lshl_b32 s56, s54, 24
    s_lshl_b32 s50, s55, 15
    s_add_u32 s56, s56, s50
    s_lshl_b32 s58, s3, 13
    s_add_u32 s56, s56, s58
    s_add_u32 s56, s56, 15728640
    v_add_u32 v7, 0, v52
    v_xor_b32 v7, v7, v53
    v_lshl_add_u32 v44, v7, 4, v6
    v_add_u32 v7, 4, v52
    v_xor_b32 v7, v7, v53
    v_lshl_add_u32 v45, v7, 4, v6
    v_add_u32 v7, 8, v52
    v_xor_b32 v7, v7, v53
    v_lshl_add_u32 v46, v7, 4, v6
    v_add_u32 v7, 12, v52
    v_xor_b32 v7, v7, v53
    v_lshl_add_u32 v47, v7, 4, v6
    v_add_u32 v7, 0, v52
    v_lshlrev_b32 v7, 1, v7
    v_xor_b32 v7, v7, v53
    v_lshl_add_u32 v48, v7, 4, v6
    v_add_u32 v7, 4, v52
    v_lshlrev_b32 v7, 1, v7
    v_xor_b32 v7, v7, v53
    v_lshl_add_u32 v49, v7, 4, v6
    s_mov_b32 s44, s2
    s_mov_b32 s96, 0
    s_mov_b32 s39, 0x20000
    s_mov_b32 s43, 0x20000
    s_mov_b32 s42, 4194304
    s_bfe_u32 s60, s2, 0x40003
    s_lshr_b32 s50, s2, 7
    s_lshl_b32 s51, s50, 2
    s_add_u32 s51, s51, s2
    s_and_b32 s51, s51, 7
    s_lshl_b32 s50, s50, 3
    s_add_u32 s61, s50, s51
    s_mov_b64 s[36:37], s[12:13]
    s_mov_b32 s38, 8388608
    s_lshl_b32 s59, s60, 2
    s_add_u32 s59, s59, s3
    s_mul_i32 s49, s59, 131072
    s_add_u32 s52, s2, 4
    s_and_b32 s52, s52, 7
    s_lshl_b32 s52, s52, 7
    s_add_u32 s91, s49, s52
    s_add_u32 s91, s91, 1024
    s_and_b32 s52, s2, 7
    s_lshl_b32 s52, s52, 7
    s_add_u32 s49, s49, s52
    v_mul_u32_u24 v3, 16384, v4
    v_lshl_add_u32 v3, v5, 4, v3
    v_lshlrev_b32 v6, 8, v53
    v_add_u32 v6, s58, v6
    v_add_u32 v7, 0, v52
    v_xor_b32 v7, v7, v53
    v_lshl_add_u32 v36, v7, 4, v6
    v_add_u32 v7, 4, v52
    v_xor_b32 v7, v7, v53
    v_lshl_add_u32 v37, v7, 4, v6
    v_add_u32 v7, 8, v52
    v_xor_b32 v7, v7, v53
    v_lshl_add_u32 v38, v7, 4, v6
    v_add_u32 v7, 12, v52
    v_xor_b32 v7, v7, v53
    v_lshl_add_u32 v39, v7, 4, v6
    v_lshrrev_b32 v6, 2, v53
    v_lshl_add_u32 v6, v52, 2, v6
    v_and_b32 v7, 7, v6
    v_lshlrev_b32 v7, 1, v7
    v_bfe_u32 v16, v53, 1, 1
    s_lshl_b32 s51, s3, 2
    v_add_u32 v16, s51, v16
    v_and_b32 v17, 1, v53
    v_lshlrev_b32 v17, 3, v17
    v_lshl_add_u32 v17, v6, 8, v17
    v_xor_b32 v18, v16, v7
    v_lshl_add_u32 v40, v18, 4, v17
    v_add_u32 v16, 2, v16
    v_xor_b32 v18, v16, v7
    v_lshl_add_u32 v41, v18, 4, v17
    v_and_b32 v7, 7, v53
    v_mul_u32_u24 v42, 288, v7
    v_lshl_add_u32 v42, v52, 4, v42
    v_add_u32 v42, 69632, v42
    v_lshl_add_u32 v43, v52, 3, v7
    v_lshlrev_b32 v43, 4, v43
    v_add_u32 v43, 71936, v43
    v_bfe_u32 v16, v53, 3, 1
    s_lshl_b32 s51, s3, 9
    v_lshl_add_u32 v54, v16, 3, v43
    v_add_u32 v54, s51, v54
    v_lshlrev_b32 v55, 5, v7
    v_add_u32 v55, 73984, v55
    s_lshl_b32 s51, s3, 3
    v_add_u32 v61, s51, v55
    v_lshlrev_b32 v56, 14, v4
    v_lshl_add_u32 v56, v5, 4, v56
    v_and_b32 v57, 3, v5
    v_lshl_add_u32 v57, v57, 4, v4
    v_lshrrev_b32 v16, 2, v5
    v_lshl_add_u32 v57, v16, 3, v57
    v_lshlrev_b32 v57, 2, v57
    v_lshlrev_b32 v58, 4, v0
    s_mul_i32 s51, s3, 576
    s_add_u32 s51, s51, 69632
    v_lshl_add_u32 v59, v0, 2, s51
    s_lshl_b32 s57, s54, 13
    s_lshl_b32 s51, s3, 11
    s_add_u32 s57, s57, s51
    s_add_u32 s57, s57, 32768
    s_add_u32 s53, s57, 0x8000
    s_and_b32 s94, s44, 7
    s_lshl_b32 s94, s94, 17
    s_lshr_b32 s51, s44, 3
    s_lshl_b32 s51, s51, 9
    s_add_u32 s94, s94, s51
    s_lshr_b32 s51, s3, 1
    s_lshl_b32 s51, s51, 13
    s_add_u32 s94, s94, s51
    s_and_b32 s51, s3, 1
    s_lshl_b32 s51, s51, 8
    s_add_u32 s94, s94, s51
    s_add_u32 s94, s94, 524288
    s_add_u32 s45, s94, 2097152
    s_and_b32 s90, s44, 7
    s_lshl_b32 s90, s90, 9
    s_lshr_b32 s51, s3, 1
    s_lshl_b32 s51, s51, 8
    s_add_u32 s90, s90, s51
    s_lshr_b32 s51, s44, 3
    s_lshl_b32 s51, s51, 1
    s_and_b32 s50, s3, 1
    s_add_u32 s51, s51, s50
    s_lshl_b32 s51, s51, 3
    s_add_u32 s90, s90, s51
    s_add_u32 s90, s90, 8192
    s_mov_b32 s62, 0xff00ff00
    s_mov_b32 s63, 0xff00ff00
    s_mov_b32 s52, 0x3db504f3
    s_mov_b32 s51, 0x3fb8aa3b
    s_mov_b32 s54, 0x07060302
    s_mov_b32 s55, 0x07060100
    v_mov_b32 v232, 0
    v_mov_b32 v96, 0
    v_mov_b32 v233, 0
    v_mov_b32 v97, 0
    v_mov_b32 v234, 0
    v_mov_b32 v98, 0
    v_mov_b32 v235, 0
    v_mov_b32 v99, 0
    v_mov_b32 v236, 0
    v_mov_b32 v100, 0
    v_mov_b32 v237, 0
    v_mov_b32 v101, 0
    v_mov_b32 v238, 0
    v_mov_b32 v102, 0
    v_mov_b32 v239, 0
    v_mov_b32 v103, 0
    v_mov_b32 v240, 0
    v_mov_b32 v104, 0
    v_mov_b32 v241, 0
    v_mov_b32 v105, 0
    v_mov_b32 v242, 0
    v_mov_b32 v106, 0
    v_mov_b32 v243, 0
    v_mov_b32 v107, 0
    v_mov_b32 v244, 0
    v_mov_b32 v108, 0
    v_mov_b32 v245, 0
    v_mov_b32 v109, 0
    v_mov_b32 v246, 0
    v_mov_b32 v110, 0
    v_mov_b32 v247, 0
    v_mov_b32 v111, 0
    s_waitcnt vmcnt(7)
    buffer_load_dwordx4 v[160:163], v2, s[28:31], s48 offen nt
    s_addk_i32 s48, 8192
    s_waitcnt vmcnt(7)
    buffer_load_dwordx4 v[164:167], v2, s[28:31], s48 offen nt
    s_addk_i32 s48, 8192
    s_waitcnt vmcnt(7)
    buffer_load_dwordx4 v[168:171], v2, s[28:31], s48 offen nt
    s_addk_i32 s48, 8192
    s_waitcnt vmcnt(7)
    buffer_load_dwordx4 v[172:175], v2, s[28:31], s48 offen nt
    s_addk_i32 s48, 8192
    s_waitcnt vmcnt(7)
    buffer_load_dwordx4 v[176:179], v2, s[28:31], s48 offen nt
    s_addk_i32 s48, 8192
    s_waitcnt vmcnt(7)
    buffer_load_dwordx4 v[180:183], v2, s[28:31], s48 offen nt
    s_addk_i32 s48, 8192
    s_waitcnt vmcnt(7)
    buffer_load_dwordx4 v[184:187], v2, s[28:31], s48 offen nt
    s_addk_i32 s48, 8192
    s_waitcnt vmcnt(7)
    buffer_load_dwordx4 v[188:191], v2, s[28:31], s48 offen nt
    s_barrier
    ds_read_b128 v[28:31], v60 offset:0
    ds_read_b128 v[32:35], v60 offset:16
    s_waitcnt lgkmcnt(0)
    s_add_u32 s46, s47, 0x9e3779b1
    v_perm_b32 v16, v28, v28, v8
    v_perm_b32 v17, v28, v28, v9
    v_perm_b32 v18, v28, v28, v10
    v_perm_b32 v19, v28, v28, v11
    v_perm_b32 v20, v28, v28, v12
    v_perm_b32 v21, v28, v28, v13
    v_perm_b32 v22, v28, v28, v14
    v_perm_b32 v23, v28, v28, v15
    v_mfma_f32_16x16x32_bf16 v[24:27], v[16:19], v[128:131], 0
    v_perm_b32 v16, v29, v29, v8
    v_perm_b32 v17, v29, v29, v9
    v_perm_b32 v18, v29, v29, v10
    v_perm_b32 v19, v29, v29, v11
    v_mfma_f32_16x16x32_bf16 v[24:27], v[20:23], v[132:135], v[24:27]
    v_perm_b32 v20, v29, v29, v12
    v_perm_b32 v21, v29, v29, v13
    v_perm_b32 v22, v29, v29, v14
    v_perm_b32 v23, v29, v29, v15
    v_mfma_f32_16x16x32_bf16 v[24:27], v[16:19], v[136:139], v[24:27]
    v_perm_b32 v16, v30, v30, v8
    v_perm_b32 v17, v30, v30, v9
    v_perm_b32 v18, v30, v30, v10
    v_perm_b32 v19, v30, v30, v11
    v_mfma_f32_16x16x32_bf16 v[24:27], v[20:23], v[140:143], v[24:27]
    v_perm_b32 v20, v30, v30, v12
    v_perm_b32 v21, v30, v30, v13
    v_perm_b32 v22, v30, v30, v14
    v_perm_b32 v23, v30, v30, v15
    v_mfma_f32_16x16x32_bf16 v[24:27], v[16:19], v[144:147], v[24:27]
    v_perm_b32 v16, v31, v31, v8
    v_perm_b32 v17, v31, v31, v9
    v_perm_b32 v18, v31, v31, v10
    v_perm_b32 v19, v31, v31, v11
    v_mfma_f32_16x16x32_bf16 v[24:27], v[20:23], v[148:151], v[24:27]
    v_perm_b32 v20, v31, v31, v12
    v_perm_b32 v21, v31, v31, v13
    v_perm_b32 v22, v31, v31, v14
    v_perm_b32 v23, v31, v31, v15
    v_mfma_f32_16x16x32_bf16 v[24:27], v[16:19], v[152:155], v[24:27]
    v_perm_b32 v16, v32, v32, v8
    v_perm_b32 v17, v32, v32, v9
    v_perm_b32 v18, v32, v32, v10
    v_perm_b32 v19, v32, v32, v11
    v_mfma_f32_16x16x32_bf16 v[24:27], v[20:23], v[156:159], v[24:27]
    v_perm_b32 v20, v32, v32, v12
    v_perm_b32 v21, v32, v32, v13
    v_perm_b32 v22, v32, v32, v14
    v_perm_b32 v23, v32, v32, v15
    s_waitcnt vmcnt(7)
    v_mfma_f32_16x16x32_bf16 v[24:27], v[16:19], v[160:163], v[24:27]
    v_perm_b32 v16, v33, v33, v8
    v_perm_b32 v17, v33, v33, v9
    v_perm_b32 v18, v33, v33, v10
    v_perm_b32 v19, v33, v33, v11
    s_mov_b64 s[28:29], s[6:7]
    s_mov_b32 s30, 67108864
    s_mov_b32 m0, s58
    s_nop 0
    buffer_load_dwordx4 v44, s[28:31], s56 offen nt lds
    s_waitcnt vmcnt(7)
    v_mfma_f32_16x16x32_bf16 v[24:27], v[20:23], v[164:167], v[24:27]
    v_perm_b32 v20, v33, v33, v12
    v_perm_b32 v21, v33, v33, v13
    v_perm_b32 v22, v33, v33, v14
    v_perm_b32 v23, v33, v33, v15
    buffer_load_dwordx4 v45, s[28:31], s56 offen offset:1024 nt lds
    s_waitcnt vmcnt(7)
    v_mfma_f32_16x16x32_bf16 v[24:27], v[16:19], v[168:171], v[24:27]
    v_perm_b32 v16, v34, v34, v8
    v_perm_b32 v17, v34, v34, v9
    v_perm_b32 v18, v34, v34, v10
    v_perm_b32 v19, v34, v34, v11
    buffer_load_dwordx4 v46, s[28:31], s56 offen offset:2048 nt lds
    s_waitcnt vmcnt(7)
    v_mfma_f32_16x16x32_bf16 v[24:27], v[20:23], v[172:175], v[24:27]
    v_perm_b32 v20, v34, v34, v12
    v_perm_b32 v21, v34, v34, v13
    v_perm_b32 v22, v34, v34, v14
    v_perm_b32 v23, v34, v34, v15
    buffer_load_dwordx4 v47, s[28:31], s56 offen offset:3072 nt lds
    s_waitcnt vmcnt(7)
    v_mfma_f32_16x16x32_bf16 v[24:27], v[16:19], v[176:179], v[24:27]
    v_perm_b32 v16, v35, v35, v8
    v_perm_b32 v17, v35, v35, v9
    v_perm_b32 v18, v35, v35, v10
    v_perm_b32 v19, v35, v35, v11
    s_addk_i32 m0, 0x1000
    s_addk_i32 s56, 0x1000
    buffer_load_dwordx4 v44, s[28:31], s56 offen nt lds
    s_waitcnt vmcnt(7)
    v_mfma_f32_16x16x32_bf16 v[24:27], v[20:23], v[180:183], v[24:27]
    v_perm_b32 v20, v35, v35, v12
    v_perm_b32 v21, v35, v35, v13
    v_perm_b32 v22, v35, v35, v14
    v_perm_b32 v23, v35, v35, v15
    buffer_load_dwordx4 v45, s[28:31], s56 offen offset:1024 nt lds
    s_waitcnt vmcnt(7)
    v_mfma_f32_16x16x32_bf16 v[24:27], v[16:19], v[184:187], v[24:27]
    buffer_load_dwordx4 v46, s[28:31], s56 offen offset:2048 nt lds
    s_waitcnt vmcnt(7)
    v_mfma_f32_16x16x32_bf16 v[24:27], v[20:23], v[188:191], v[24:27]
    buffer_load_dwordx4 v47, s[28:31], s56 offen offset:3072 nt lds
    s_lshl_b32 s50, s3, 10
    s_add_u32 s50, s50, 65536
    v_lshl_add_u32 v6, v0, 4, s50
    s_nop 3
    ds_write_b128 v6, v[24:27]
    s_waitcnt lgkmcnt(0)
    s_barrier
    s_waitcnt vmcnt(7)
    s_mov_b64 s[28:29], s[8:9]
    s_add_u32 m0, s58, 32768
    s_sub_u32 s56, s56, 0x1000
    buffer_load_dwordx4 v48, s[28:31], s56 offen nt lds
    s_waitcnt vmcnt(7)
    buffer_load_dwordx4 v49, s[28:31], s56 offen offset:1024 nt lds
    s_waitcnt vmcnt(7)
    buffer_load_dwordx4 v48, s[28:31], s56 offen offset:2048 nt lds
    s_waitcnt vmcnt(7)
    buffer_load_dwordx4 v49, s[28:31], s56 offen offset:3072 nt lds
    s_waitcnt vmcnt(7)
    s_addk_i32 m0, 0x1000
    s_addk_i32 s56, 0x1000
    buffer_load_dwordx4 v48, s[28:31], s56 offen nt lds
    s_waitcnt vmcnt(7)
    buffer_load_dwordx4 v49, s[28:31], s56 offen offset:1024 nt lds
    s_waitcnt vmcnt(7)
    buffer_load_dwordx4 v48, s[28:31], s56 offen offset:2048 nt lds
    s_waitcnt vmcnt(7)
    buffer_load_dwordx4 v49, s[28:31], s56 offen offset:3072 nt lds
    s_waitcnt vmcnt(3)
    s_and_b32 s92, s2, 7
    s_lshl_b32 s92, s92, 8
    s_add_u32 s92, s92, 4096
    v_and_b32 v248, 31, v0
    v_lshlrev_b32 v248, 3, v248
    buffer_load_dwordx2 v[248:249], v248, s[40:43], s92 offen sc1
    buffer_load_dwordx4 v[128:131], v58, s[40:43], s57 offen offset:0 sc1
    buffer_load_dwordx4 v[132:135], v58, s[40:43], s53 offen offset:0 sc1
    buffer_load_dwordx4 v[136:139], v58, s[40:43], s57 offen offset:1024 sc1
    buffer_load_dwordx4 v[140:143], v58, s[40:43], s53 offen offset:1024 sc1
    ds_read_b128 v[160:163], v36 offset:0
    ds_read_b128 v[164:167], v37 offset:0
    ds_read_b128 v[168:171], v38 offset:0
    ds_read_b128 v[172:175], v39 offset:0
    ds_read_b128 v[176:179], v36 offset:4096
    ds_read_b128 v[180:183], v37 offset:4096
    ds_read_b128 v[184:187], v38 offset:4096
    ds_read_b128 v[188:191], v39 offset:4096
    s_waitcnt vmcnt(0)
    s_branch L_Aq1
L_Aq0:
    s_add_u32 s96, s96, 1
    s_cmp_gt_u32 s96, 0x20000
    s_cbranch_scc1 L_fin
    s_sleep 1
    buffer_load_dwordx4 v[128:131], v58, s[40:43], s57 offen offset:0 sc1
    buffer_load_dwordx4 v[132:135], v58, s[40:43], s53 offen offset:0 sc1
    buffer_load_dwordx4 v[136:139], v58, s[40:43], s57 offen offset:1024 sc1
    buffer_load_dwordx4 v[140:143], v58, s[40:43], s53 offen offset:1024 sc1
    s_waitcnt vmcnt(0)
L_Aq1:
    v_bitop3_b32 v6, v129, v131, s46 bitop3:0x7e
    v_bitop3_b32 v6, v6, v133, s46 bitop3:0xf6
    v_bitop3_b32 v6, v6, v135, s46 bitop3:0xf6
    v_bitop3_b32 v6, v6, v137, s46 bitop3:0xf6
    v_bitop3_b32 v6, v6, v139, s46 bitop3:0xf6
    v_bitop3_b32 v6, v6, v141, s46 bitop3:0xf6
    v_bitop3_b32 v6, v6, v143, s46 bitop3:0xf6
    v_cmp_ne_u32 vcc, 0, v6
    s_cbranch_vccnz L_Aq0
    v_add_f32 v16, v128, v132
    v_add_f32 v17, v130, v134
    v_add_f32 v18, v136, v140
    v_add_f32 v19, v138, v142
    v_cvt_pk_bf16_f32 v16, v16, v17
    v_cvt_pk_bf16_f32 v18, v18, v19
    ds_write2_b32 v59, v16, v18 offset1:72
    s_waitcnt lgkmcnt(0)
    s_barrier
    ds_read_b128 v[144:147], v42 offset:0
    ds_read_b128 v[148:151], v42 offset:64
    ds_read_b128 v[152:155], v42 offset:128
    ds_read_b128 v[156:159], v42 offset:192
    buffer_load_dwordx4 v[64:67], v3, s[36:39], s49 offen nt
    buffer_load_dwordx4 v[68:71], v3, s[36:39], s91 offen nt
    buffer_load_dwordx4 v[72:75], v3, s[36:39], s49 offen offset:2048 nt
    s_addk_i32 s49, 0x1000
    s_waitcnt lgkmcnt(3)
    v_mfma_f32_16x16x32_bf16 v[28:31], v[160:163], v[144:147], 0
    v_mfma_f32_16x16x32_bf16 v[32:35], v[176:179], v[144:147], 0
    ds_read_b64_tr_b16 v[192:193], v40 offset:32768
    ds_read_b64_tr_b16 v[194:195], v40 offset:36864
    ds_read_b64_tr_b16 v[196:197], v41 offset:32768
    ds_read_b64_tr_b16 v[198:199], v41 offset:36864
    s_waitcnt lgkmcnt(6)
    v_mfma_f32_16x16x32_bf16 v[28:31], v[164:167], v[148:151], v[28:31]
    v_mfma_f32_16x16x32_bf16 v[32:35], v[180:183], v[148:151], v[32:35]
    ds_read_b64_tr_b16 v[200:201], v40 offset:40960
    ds_read_b64_tr_b16 v[202:203], v40 offset:45056
    ds_read_b64_tr_b16 v[204:205], v41 offset:40960
    ds_read_b64_tr_b16 v[206:207], v41 offset:45056
    s_waitcnt lgkmcnt(9)
    v_mfma_f32_16x16x32_bf16 v[28:31], v[168:171], v[152:155], v[28:31]
    v_mfma_f32_16x16x32_bf16 v[32:35], v[184:187], v[152:155], v[32:35]
    ds_read_b64_tr_b16 v[208:209], v40 offset:49152
    ds_read_b64_tr_b16 v[210:211], v40 offset:53248
    ds_read_b64_tr_b16 v[212:213], v41 offset:49152
    ds_read_b64_tr_b16 v[214:215], v41 offset:53248
    s_waitcnt lgkmcnt(12)
    v_mfma_f32_16x16x32_bf16 v[28:31], v[172:175], v[156:159], v[28:31]
    v_mfma_f32_16x16x32_bf16 v[32:35], v[188:191], v[156:159], v[32:35]
    ds_read_b64_tr_b16 v[216:217], v40 offset:57344
    ds_read_b64_tr_b16 v[218:219], v40 offset:61440
    ds_read_b64_tr_b16 v[220:221], v41 offset:57344
    ds_read_b64_tr_b16 v[222:223], v41 offset:61440
    s_nop 3
    v_cndmask_b32 v224, v28, v32, s[62:63]
    v_cndmask_b32 v225, v29, v33, s[62:63]
    v_cndmask_b32 v226, v30, v34, s[62:63]
    v_cndmask_b32 v227, v31, v35, s[62:63]
    v_cvt_pk_bf16_f32 v28, v224, v225
    v_cvt_pk_bf16_f32 v29, v226, v227
    v_lshlrev_b32 v224, 16, v28
    v_and_b32 v225, 0xffff0000, v28
    v_lshlrev_b32 v226, 16, v29
    v_and_b32 v227, 0xffff0000, v29
    v_mul_f32 v224, s52, v224
    v_mul_f32 v225, s52, v225
    v_mul_f32 v226, s52, v226
    v_mul_f32 v227, s52, v227
    v_cvt_pk_bf16_f32 v28, v224, v225
    v_cvt_pk_bf16_f32 v29, v226, v227
    v_lshlrev_b32 v224, 16, v28
    v_and_b32 v225, 0xffff0000, v28
    v_lshlrev_b32 v226, 16, v29
    v_and_b32 v227, 0xffff0000, v29
    v_max3_f32 v6, v224, v225, v226
    v_max_f32 v6, v6, v227
    s_nop 1
    v_max_f32_dpp v6, v6, v6 row_ror:8 row_mask:0xf bank_mask:0xf
    v_mov_b32 v7, v6
    s_nop 1
    v_permlane16_swap_b32 v6, v7
    v_max_f32 v6, v6, v7
    v_mov_b32 v7, v6
    s_nop 1
    v_permlane32_swap_b32 v6, v7
    v_max_f32 v6, v6, v7
    v_mul_f32 v6, s51, v6
    v_fma_f32 v224, v224, s51, -v6
    v_fma_f32 v225, v225, s51, -v6
    v_fma_f32 v226, v226, s51, -v6
    v_fma_f32 v227, v227, s51, -v6
    v_exp_f32 v224, v224
    v_exp_f32 v225, v225
    v_exp_f32 v226, v226
    v_exp_f32 v227, v227
    v_cvt_pk_bf16_f32 v28, v224, v225
    v_cvt_pk_bf16_f32 v29, v226, v227
    ds_write_b64 v54, v[28:29]
    v_pk_add_f32 v[224:225], v[224:225], v[226:227]
    v_add_f32 v7, v224, v225
    s_nop 1
    v_add_f32_dpp v7, v7, v7 row_ror:8 row_mask:0xf bank_mask:0xf
    v_mov_b32 v17, v7
    s_nop 1
    v_permlane16_swap_b32 v7, v17
    v_add_f32 v7, v7, v17
    v_mov_b32 v17, v7
    s_nop 1
    v_permlane32_swap_b32 v7, v17
    v_add_f32 v7, v7, v17
    ds_write_b64 v61, v[6:7]
    s_waitcnt lgkmcnt(0)
    s_barrier
    s_not_b64 exec, s[62:63]
    ds_read_b128 v[96:99], v43 offset:0
    ds_read_b128 v[100:103], v43 offset:512
    ds_read_b128 v[104:107], v43 offset:1024
    ds_read_b128 v[108:111], v43 offset:1536
    s_mov_b64 exec, s[62:63]
    ds_read_b128 v[232:235], v43 offset:0
    ds_read_b128 v[236:239], v43 offset:512
    ds_read_b128 v[240:243], v43 offset:1024
    ds_read_b128 v[244:247], v43 offset:1536
    s_mov_b64 exec, -1
    ds_read_b128 v[224:227], v55
    ds_read_b128 v[228:231], v55 offset:16
    s_waitcnt lgkmcnt(6)
    v_mfma_f32_16x16x32_bf16 v[160:163], v[192:195], v[96:99], 0
    v_mfma_f32_16x16x32_bf16 v[164:167], v[200:203], v[100:103], 0
    v_mfma_f32_16x16x32_bf16 v[168:171], v[208:211], v[104:107], 0
    v_mfma_f32_16x16x32_bf16 v[172:175], v[216:219], v[108:111], 0
    s_waitcnt lgkmcnt(0)
    v_mfma_f32_16x16x32_bf16 v[160:163], v[196:199], v[232:235], v[160:163]
    v_mfma_f32_16x16x32_bf16 v[164:167], v[204:207], v[236:239], v[164:167]
    v_mfma_f32_16x16x32_bf16 v[168:171], v[212:215], v[240:243], v[168:171]
    v_mfma_f32_16x16x32_bf16 v[172:175], v[220:223], v[244:247], v[172:175]
    v_max3_f32 v24, v224, v226, v228
    v_max_f32 v24, v24, v230
    v_sub_f32 v224, v224, v24
    v_sub_f32 v226, v226, v24
    v_sub_f32 v228, v228, v24
    v_sub_f32 v230, v230, v24
    v_exp_f32 v224, v224
    v_exp_f32 v226, v226
    v_exp_f32 v228, v228
    v_exp_f32 v230, v230
    v_mul_f32 v26, v224, v225
    v_fmac_f32 v26, v226, v227
    v_fmac_f32 v26, v228, v229
    v_fmac_f32 v26, v230, v231
    v_rcp_f32 v25, v26
    v_log_f32 v26, v26
    v_pk_mul_f32 v[28:29], v[160:161], v[224:225] op_sel_hi:[1,0]
    v_pk_mul_f32 v[30:31], v[162:163], v[224:225] op_sel_hi:[1,0]
    v_add_f32 v26, v26, v24
    ds_bpermute_b32 v21, v57, v26
    v_pk_fma_f32 v[28:29], v[164:165], v[226:227], v[28:29] op_sel_hi:[1,0,1]
    v_pk_fma_f32 v[30:31], v[166:167], v[226:227], v[30:31] op_sel_hi:[1,0,1]
    v_pk_fma_f32 v[28:29], v[168:169], v[228:229], v[28:29] op_sel_hi:[1,0,1]
    v_pk_fma_f32 v[30:31], v[170:171], v[228:229], v[30:31] op_sel_hi:[1,0,1]
    v_pk_fma_f32 v[28:29], v[172:173], v[230:231], v[28:29] op_sel_hi:[1,0,1]
    v_pk_fma_f32 v[30:31], v[174:175], v[230:231], v[30:31] op_sel_hi:[1,0,1]
    v_pk_mul_f32 v[28:29], v[28:29], v[24:25] op_sel:[0,1] op_sel_hi:[1,1]
    v_pk_mul_f32 v[30:31], v[30:31], v[24:25] op_sel:[0,1] op_sel_hi:[1,1]
    v_mov_b32 v27, s46
    ds_bpermute_b32 v16, v57, v28
    ds_bpermute_b32 v18, v57, v29
    ds_bpermute_b32 v20, v57, v30
    ds_bpermute_b32 v22, v57, v31
    s_waitcnt lgkmcnt(4)
    v_perm_b32 v17, v27, v21, s54
    v_perm_b32 v19, v27, v21, s55
    v_perm_b32 v23, v27, v21, s55
    v_perm_b32 v21, v27, v21, s54
    s_waitcnt lgkmcnt(2)
    buffer_store_dwordx4 v[16:19], v56, s[40:43], s94 offen
    s_waitcnt lgkmcnt(0)
    buffer_store_dwordx4 v[20:23], v56, s[40:43], s94 offen offset:128
    s_getreg_b32 s92, hwreg(HW_REG_XCC_ID, 0, 4)
    v_xor_b32 v248, s92, v248
    v_bitop3_b32 v248, v248, v249, s46 bitop3:0xf6
    v_cmp_ne_u32 vcc, 0, v248
    s_nop 0
    s_or_b32 s93, vcc_lo, vcc_hi
    s_cmp_eq_u32 s93, 0
    s_cbranch_scc1 L_A9
    buffer_store_dwordx4 v[16:19], v56, s[40:43], s45 offen sc1
    buffer_store_dwordx4 v[20:23], v56, s[40:43], s45 offen offset:128 sc1
L_A9:
    s_barrier
L_Aret:
    buffer_load_dwordx4 v[76:79], v3, s[36:39], s91 offen offset:2048 nt
    s_addk_i32 s91, 0x1000
    buffer_load_dwordx4 v[80:83], v3, s[36:39], s49 offen nt
    buffer_load_dwordx4 v[84:87], v3, s[36:39], s91 offen nt
    buffer_load_dwordx4 v[88:91], v3, s[36:39], s49 offen offset:2048 nt
    s_addk_i32 s49, 0x1000
    buffer_load_dwordx4 v[92:95], v3, s[36:39], s91 offen offset:2048 nt
    s_addk_i32 s91, 0x1000
    buffer_load_dwordx4 v[96:99], v3, s[36:39], s49 offen nt
    buffer_load_dwordx4 v[100:103], v3, s[36:39], s91 offen nt
    buffer_load_dwordx4 v[104:107], v3, s[36:39], s49 offen offset:2048 nt
    s_addk_i32 s49, 0x1000
    s_lshl_b32 s50, s3, 11
    s_add_u32 s50, s50, 81920
    v_lshl_add_u32 v61, v0, 4, s50
    s_lshl_b32 s57, s59, 9
    s_add_u32 s57, s57, 229376
    s_add_u32 s58, s57, 0x8000
    s_mov_b32 s54, 0x05040100
    v_bfe_u32 v60, v0, 1, 3
    v_and_b32 v6, 1, v0
    v_lshl_add_u32 v60, v6, 3, v60
    v_and_b32 v6, 16, v0
    v_add_u32 v60, v60, v6
    v_lshlrev_b32 v60, 4, v60
    v_lshlrev_b32 v63, 4, v4
    s_waitcnt vmcnt(7)
    buffer_load_dwordx4 v[108:111], v3, s[36:39], s91 offen offset:2048 nt
    s_addk_i32 s91, 0x1000
    s_waitcnt vmcnt(7)
    buffer_load_dwordx4 v[28:31], v60, s[40:43], s57 offen sc1
    buffer_load_dwordx4 v[32:35], v60, s[40:43], s58 offen sc1
    buffer_load_dwordx4 v[112:115], v3, s[36:39], s49 offen nt
    s_waitcnt vmcnt(9)
    buffer_load_dwordx4 v[116:119], v3, s[36:39], s91 offen nt
    s_waitcnt vmcnt(9)
    buffer_load_dwordx4 v[120:123], v3, s[36:39], s49 offen offset:2048 nt
    s_waitcnt vmcnt(9)
    buffer_load_dwordx4 v[124:127], v3, s[36:39], s91 offen offset:2048 nt
    s_waitcnt vmcnt(4)
L_Qp1:
    v_bitop3_b32 v6, v29, v31, s46 bitop3:0x7e
    v_bitop3_b32 v6, v6, v33, s46 bitop3:0xf6
    v_bitop3_b32 v6, v6, v35, s46 bitop3:0xf6
    v_cmp_lt_u32 vcc, 0xffff, v6
    s_cbranch_vccnz L_Qp0
L_Qp2:
    v_perm_b32 v6, v29, v31, s54
    v_perm_b32 v7, v33, v35, s54
    v_sub_f32 v6, v7, v6
    v_exp_f32 v6, v6
    v_sub_f32 v28, v28, v32
    v_add_f32 v6, 1.0, v6
    v_rcp_f32 v6, v6
    v_sub_f32 v30, v30, v34
    v_fma_f32 v28, v28, v6, v32
    v_fma_f32 v30, v30, v6, v34
    v_cvt_pk_bf16_f32 v18, v28, v30
    ds_bpermute_b32 v36, v63, v18 offset:0
    ds_bpermute_b32 v37, v63, v18 offset:4
    ds_bpermute_b32 v38, v63, v18 offset:8
    ds_bpermute_b32 v39, v63, v18 offset:12
    s_waitcnt lgkmcnt(0)
    v_perm_b32 v16, v36, v36, v8
    v_perm_b32 v17, v36, v36, v9
    v_perm_b32 v18, v36, v36, v10
    v_perm_b32 v19, v36, v36, v11
    v_perm_b32 v20, v36, v36, v12
    v_perm_b32 v21, v36, v36, v13
    v_perm_b32 v22, v36, v36, v14
    v_perm_b32 v23, v36, v36, v15
    v_mfma_f32_16x16x32_bf16 v[24:27], v[16:19], v[64:67], 0
    v_mfma_f32_16x16x32_bf16 v[52:55], v[16:19], v[68:71], 0
    v_perm_b32 v16, v37, v37, v8
    v_perm_b32 v17, v37, v37, v9
    v_perm_b32 v18, v37, v37, v10
    v_perm_b32 v19, v37, v37, v11
    v_mfma_f32_16x16x32_bf16 v[24:27], v[20:23], v[72:75], v[24:27]
    v_mfma_f32_16x16x32_bf16 v[52:55], v[20:23], v[76:79], v[52:55]
    v_perm_b32 v20, v37, v37, v12
    v_perm_b32 v21, v37, v37, v13
    v_perm_b32 v22, v37, v37, v14
    v_perm_b32 v23, v37, v37, v15
    v_mfma_f32_16x16x32_bf16 v[24:27], v[16:19], v[80:83], v[24:27]
    v_mfma_f32_16x16x32_bf16 v[52:55], v[16:19], v[84:87], v[52:55]
    v_perm_b32 v16, v38, v38, v8
    v_perm_b32 v17, v38, v38, v9
    v_perm_b32 v18, v38, v38, v10
    v_perm_b32 v19, v38, v38, v11
    v_mfma_f32_16x16x32_bf16 v[24:27], v[20:23], v[88:91], v[24:27]
    v_mfma_f32_16x16x32_bf16 v[52:55], v[20:23], v[92:95], v[52:55]
    v_perm_b32 v20, v38, v38, v12
    v_perm_b32 v21, v38, v38, v13
    v_perm_b32 v22, v38, v38, v14
    v_perm_b32 v23, v38, v38, v15
    v_mfma_f32_16x16x32_bf16 v[24:27], v[16:19], v[96:99], v[24:27]
    v_mfma_f32_16x16x32_bf16 v[52:55], v[16:19], v[100:103], v[52:55]
    v_perm_b32 v16, v39, v39, v8
    v_perm_b32 v17, v39, v39, v9
    v_perm_b32 v18, v39, v39, v10
    v_perm_b32 v19, v39, v39, v11
    v_mfma_f32_16x16x32_bf16 v[24:27], v[20:23], v[104:107], v[24:27]
    v_mfma_f32_16x16x32_bf16 v[52:55], v[20:23], v[108:111], v[52:55]
    v_perm_b32 v20, v39, v39, v12
    v_perm_b32 v21, v39, v39, v13
    v_perm_b32 v22, v39, v39, v14
    v_perm_b32 v23, v39, v39, v15
    s_waitcnt vmcnt(3)
    v_mfma_f32_16x16x32_bf16 v[24:27], v[16:19], v[112:115], v[24:27]
    s_waitcnt vmcnt(2)
    v_mfma_f32_16x16x32_bf16 v[52:55], v[16:19], v[116:119], v[52:55]
    s_waitcnt vmcnt(1)
    v_mfma_f32_16x16x32_bf16 v[24:27], v[20:23], v[120:123], v[24:27]
    s_waitcnt vmcnt(0)
    v_mfma_f32_16x16x32_bf16 v[52:55], v[20:23], v[124:127], v[52:55]
    s_nop 5
    ds_write_b128 v61, v[24:27]
    s_nop 0
    ds_write_b128 v61, v[52:55] offset:1024
    s_waitcnt lgkmcnt(0)
    s_barrier
    s_branch L_glob
L_Qp0:
    s_add_u32 s96, s96, 1
    s_cmp_gt_u32 s96, 0x20000
    s_cbranch_scc1 L_fin
    buffer_load_dwordx4 v[28:31], v60, s[40:43], s57 offen sc1
    buffer_load_dwordx4 v[32:35], v60, s[40:43], s58 offen sc1
    s_waitcnt vmcnt(0)
    s_branch L_Qp1
L_COMM:
    v_add_u32 v12, 74240, v11
    s_mov_b32 s55, 1
    s_waitcnt lgkmcnt(0)
    s_load_dword s47, s[26:27], 0
    s_waitcnt vmcnt(0)
L_Cln:
    v_lshlrev_b32 v64, 16, v16
    v_and_b32 v65, 0xffff0000, v16
    v_lshlrev_b32 v66, 16, v17
    v_and_b32 v67, 0xffff0000, v17
    v_lshlrev_b32 v68, 16, v18
    v_and_b32 v69, 0xffff0000, v18
    v_lshlrev_b32 v70, 16, v19
    v_and_b32 v71, 0xffff0000, v19
    v_lshlrev_b32 v72, 16, v20
    v_and_b32 v73, 0xffff0000, v20
    v_lshlrev_b32 v74, 16, v21
    v_and_b32 v75, 0xffff0000, v21
    v_lshlrev_b32 v76, 16, v22
    v_and_b32 v77, 0xffff0000, v22
    v_lshlrev_b32 v78, 16, v23
    v_and_b32 v79, 0xffff0000, v23
    v_pk_add_f32 v[80:81], v[64:65], v[66:67]
    v_pk_add_f32 v[80:81], v[80:81], v[68:69]
    v_pk_add_f32 v[80:81], v[80:81], v[70:71]
    v_pk_add_f32 v[80:81], v[80:81], v[72:73]
    v_pk_add_f32 v[80:81], v[80:81], v[74:75]
    v_pk_add_f32 v[80:81], v[80:81], v[76:77]
    v_pk_add_f32 v[80:81], v[80:81], v[78:79]
    v_add_f32 v80, v80, v81
    s_nop 1
    v_add_f32_dpp v80, v80, v80 row_ror:8 row_mask:0xf bank_mask:0xf
    s_nop 1
    v_add_f32_dpp v80, v80, v80 row_ror:4 row_mask:0xf bank_mask:0xf
    s_nop 1
    v_add_f32_dpp v80, v80, v80 row_ror:2 row_mask:0xf bank_mask:0xf
    s_nop 1
    v_add_f32_dpp v80, v80, v80 row_ror:1 row_mask:0xf bank_mask:0xf
    s_nop 1
    v_add_f32_dpp v80, v80, v80 row_bcast:15 row_mask:0xa bank_mask:0xf
    s_nop 1
    v_add_f32_dpp v80, v80, v80 row_bcast:31 row_mask:0xc bank_mask:0xf
    s_nop 0
    v_readlane_b32 s54, v80, 63
    v_mov_b32 v82, 0x3a800000
    s_nop 0
    v_mul_f32 v82, s54, v82
    v_pk_add_f32 v[84:85], v[64:65], v[82:83] op_sel_hi:[1,0] neg_lo:[0,1] neg_hi:[0,1]
    v_pk_add_f32 v[86:87], v[66:67], v[82:83] op_sel_hi:[1,0] neg_lo:[0,1] neg_hi:[0,1]
    v_pk_add_f32 v[88:89], v[68:69], v[82:83] op_sel_hi:[1,0] neg_lo:[0,1] neg_hi:[0,1]
    v_pk_add_f32 v[90:91], v[70:71], v[82:83] op_sel_hi:[1,0] neg_lo:[0,1] neg_hi:[0,1]
    v_pk_add_f32 v[92:93], v[72:73], v[82:83] op_sel_hi:[1,0] neg_lo:[0,1] neg_hi:[0,1]
    v_pk_add_f32 v[94:95], v[74:75], v[82:83] op_sel_hi:[1,0] neg_lo:[0,1] neg_hi:[0,1]
    v_pk_add_f32 v[96:97], v[76:77], v[82:83] op_sel_hi:[1,0] neg_lo:[0,1] neg_hi:[0,1]
    v_pk_add_f32 v[98:99], v[78:79], v[82:83] op_sel_hi:[1,0] neg_lo:[0,1] neg_hi:[0,1]
    v_pk_mul_f32 v[80:81], v[84:85], v[84:85]
    v_pk_fma_f32 v[80:81], v[86:87], v[86:87], v[80:81]
    v_pk_fma_f32 v[80:81], v[88:89], v[88:89], v[80:81]
    v_pk_fma_f32 v[80:81], v[90:91], v[90:91], v[80:81]
    v_pk_fma_f32 v[80:81], v[92:93], v[92:93], v[80:81]
    v_pk_fma_f32 v[80:81], v[94:95], v[94:95], v[80:81]
    v_pk_fma_f32 v[80:81], v[96:97], v[96:97], v[80:81]
    v_pk_fma_f32 v[80:81], v[98:99], v[98:99], v[80:81]
    v_add_f32 v80, v80, v81
    v_cvt_pk_bf16_f32 v82, v82, v82
    v_lshlrev_b32 v82, 16, v82
    v_pk_add_f32 v[64:65], v[64:65], v[82:83] op_sel_hi:[1,0] neg_lo:[0,1] neg_hi:[0,1]
    v_pk_add_f32 v[66:67], v[66:67], v[82:83] op_sel_hi:[1,0] neg_lo:[0,1] neg_hi:[0,1]
    v_add_f32_dpp v80, v80, v80 row_ror:8 row_mask:0xf bank_mask:0xf
    v_pk_add_f32 v[68:69], v[68:69], v[82:83] op_sel_hi:[1,0] neg_lo:[0,1] neg_hi:[0,1]
    v_pk_add_f32 v[70:71], v[70:71], v[82:83] op_sel_hi:[1,0] neg_lo:[0,1] neg_hi:[0,1]
    v_add_f32_dpp v80, v80, v80 row_ror:4 row_mask:0xf bank_mask:0xf
    v_pk_add_f32 v[72:73], v[72:73], v[82:83] op_sel_hi:[1,0] neg_lo:[0,1] neg_hi:[0,1]
    v_pk_add_f32 v[74:75], v[74:75], v[82:83] op_sel_hi:[1,0] neg_lo:[0,1] neg_hi:[0,1]
    v_add_f32_dpp v80, v80, v80 row_ror:2 row_mask:0xf bank_mask:0xf
    v_pk_add_f32 v[76:77], v[76:77], v[82:83] op_sel_hi:[1,0] neg_lo:[0,1] neg_hi:[0,1]
    v_pk_add_f32 v[78:79], v[78:79], v[82:83] op_sel_hi:[1,0] neg_lo:[0,1] neg_hi:[0,1]
    v_add_f32_dpp v80, v80, v80 row_ror:1 row_mask:0xf bank_mask:0xf
    v_cvt_pk_bf16_f32 v24, v64, v65
    v_cvt_pk_bf16_f32 v25, v66, v67
    v_add_f32_dpp v80, v80, v80 row_bcast:15 row_mask:0xa bank_mask:0xf
    v_cvt_pk_bf16_f32 v26, v68, v69
    v_cvt_pk_bf16_f32 v27, v70, v71
    v_add_f32_dpp v80, v80, v80 row_bcast:31 row_mask:0xc bank_mask:0xf
    v_cvt_pk_bf16_f32 v28, v72, v73
    v_cvt_pk_bf16_f32 v29, v74, v75
    v_readlane_b32 s54, v80, 63
    v_mov_b32 v80, 0x3a800000
    v_cvt_pk_bf16_f32 v30, v76, v77
    v_mul_f32 v80, s54, v80
    v_cvt_pk_bf16_f32 v80, v80, v80
    v_lshlrev_b32 v80, 16, v80
    v_add_f32 v80, 0x3727c5ac, v80
    v_cvt_pk_bf16_f32 v80, v80, v80
    v_lshlrev_b32 v80, 16, v80
    v_sqrt_f32 v80, v80
    v_cvt_pk_bf16_f32 v31, v78, v79
    v_cvt_pk_bf16_f32 v80, v80, v80
    v_lshlrev_b32 v80, 16, v80
    v_rcp_f32 v80, v80
    v_lshlrev_b32 v64, 16, v24
    v_and_b32 v65, 0xffff0000, v24
    v_lshlrev_b32 v66, 16, v25
    v_and_b32 v67, 0xffff0000, v25
    v_lshlrev_b32 v68, 16, v26
    v_and_b32 v69, 0xffff0000, v26
    v_lshlrev_b32 v70, 16, v27
    v_and_b32 v71, 0xffff0000, v27
    v_lshlrev_b32 v72, 16, v28
    v_and_b32 v73, 0xffff0000, v28
    v_lshlrev_b32 v74, 16, v29
    v_and_b32 v75, 0xffff0000, v29
    v_lshlrev_b32 v76, 16, v30
    v_and_b32 v77, 0xffff0000, v30
    v_lshlrev_b32 v78, 16, v31
    v_and_b32 v79, 0xffff0000, v31
    v_pk_mul_f32 v[64:65], v[64:65], v[80:81] op_sel_hi:[1,0]
    v_pk_mul_f32 v[66:67], v[66:67], v[80:81] op_sel_hi:[1,0]
    v_pk_mul_f32 v[68:69], v[68:69], v[80:81] op_sel_hi:[1,0]
    v_pk_mul_f32 v[70:71], v[70:71], v[80:81] op_sel_hi:[1,0]
    v_pk_mul_f32 v[72:73], v[72:73], v[80:81] op_sel_hi:[1,0]
    v_pk_mul_f32 v[74:75], v[74:75], v[80:81] op_sel_hi:[1,0]
    v_pk_mul_f32 v[76:77], v[76:77], v[80:81] op_sel_hi:[1,0]
    v_pk_mul_f32 v[78:79], v[78:79], v[80:81] op_sel_hi:[1,0]
    v_cvt_pk_bf16_f32 v24, v64, v65
    v_cvt_pk_bf16_f32 v25, v66, v67
    v_cvt_pk_bf16_f32 v26, v68, v69
    v_cvt_pk_bf16_f32 v27, v70, v71
    v_cvt_pk_bf16_f32 v28, v72, v73
    v_cvt_pk_bf16_f32 v29, v74, v75
    v_cvt_pk_bf16_f32 v30, v76, v77
    v_cvt_pk_bf16_f32 v31, v78, v79
    ds_write_b128 v12, v[24:27]
    ds_write_b128 v12, v[28:31] offset:16
    s_waitcnt lgkmcnt(0)
    s_barrier
    s_setprio 0
    s_mov_b32 s44, s2
    s_mov_b32 s96, 0
    s_mov_b32 s39, 0x20000
    s_mov_b32 s43, 0x20000
    s_mov_b32 s42, 4194304
    s_bfe_u32 s60, s2, 0x40003
    s_lshr_b32 s50, s2, 7
    s_lshl_b32 s51, s50, 2
    s_add_u32 s51, s51, s2
    s_and_b32 s51, s51, 7
    s_lshl_b32 s50, s50, 3
    s_add_u32 s61, s50, s51
    s_sub_u32 s50, s2, 128
    s_mul_i32 s51, s50, 147
    s_lshr_b32 s51, s51, 10
    s_add_u32 s50, s50, s51
    s_and_b32 s51, s50, 7
    s_cmp_ge_u32 s51, 3
    s_addc_u32 s45, s50, 0
    s_bfe_u32 s50, s2, 0x40001
    s_lshl_b32 s51, s50, 3
    s_add_u32 s51, s51, 3
    s_add_u32 s99, s50, 96
    s_cmp_lt_u32 s50, 14
    s_cselect_b32 s51, s51, s99
    s_cmp_lt_u32 s2, 224
    s_cselect_b32 s45, s45, s51
    s_cselect_b32 s99, 0, 1
    s_and_b32 s99, s99, s2
    s_cmp_ge_u32 s45, 56
    s_cselect_b32 s98, 1, 0
    s_cselect_b32 s51, 56, 0
    s_sub_u32 s45, s45, s51
    v_and_b32 v5, 1, v0
    v_bfe_u32 v2, v0, 4, 1
    v_lshlrev_b32 v2, 1, v2
    v_lshl_add_u32 v2, v5, 2, v2
    s_lshl_b32 s48, s61, 7
    s_lshl_b32 s50, s60, 3
    s_add_u32 s48, s48, s50
    v_mov_b32 v3, 0
    s_mov_b32 s3, 4
    s_movk_i32 s38, 0x800
    s_mov_b64 s[36:37], s[22:23]
    s_mov_b64 s[40:41], s[26:27]
    buffer_load_short_d16_hi v3, v2, s[32:35], s48 offen
    v_bfe_u32 v4, v0, 1, 4
    v_lshlrev_b32 v4, 9, v4
    v_lshl_add_u32 v48, v5, 4, v4
    v_lshrrev_b32 v4, 5, v0
    v_xor_b32 v4, 1, v4
    v_lshl_add_u32 v48, v4, 17, v48
    v_and_b32 v5, 3, v0
    v_bfe_u32 v4, v0, 2, 1
    v_lshrrev_b32 v6, 3, v0
    v_lshl_add_u32 v4, v4, 4, v6
    v_lshlrev_b32 v4, 4, v4
    v_lshl_add_u32 v49, v5, 2, v4
    v_add_u32 v49, 81920, v49
    v_add_u32 v50, 640, v49
    v_add_u32 v51, -16384, v49
    v_add_u32 v52, 2048, v51
    v_add_u32 v53, 1024, v51
    v_add_u32 v54, 3072, v51
    v_lshlrev_b32 v9, 3, v0
    v_lshlrev_b32 v10, 4, v0
    s_lshl_b32 s50, s45, 10
    s_lshl_b32 s51, s98, 16
    s_add_u32 s50, s50, s51
    s_add_u32 s50, s50, 98304
    s_add_u32 s52, s44, 2
    s_and_b32 s52, s52, 63
    s_and_b32 s53, s44, 64
    s_or_b32 s52, s52, s53
    s_lshl_b32 s52, s52, 9
    s_add_u32 s52, s52, 32768
    s_lshr_b32 s54, s2, 7
    s_lshl_b32 s54, s54, 17
    s_lshl_b32 s80, s60, 9
    s_add_u32 s54, s54, s80
    s_add_u32 s54, s54, 1572864
    s_and_b32 s80, s2, 7
    s_lshl_b32 s80, s80, 13
    s_add_u32 s80, s80, s54
    s_add_u32 s81, s2, 4
    s_and_b32 s81, s81, 7
    s_lshl_b32 s81, s81, 13
    s_add_u32 s81, s81, s54
    s_add_u32 s81, s81, 65536
    s_lshl_b32 s58, s61, 13
    s_lshl_b32 s54, s60, 5
    s_add_u32 s58, s58, s54
    s_add_u32 s58, s58, 1572864
    s_add_u32 s46, s47, 0x9e3779b1
    v_mov_b32 v5, s46
    v_mov_b32 v7, s46
    s_getreg_b32 s53, hwreg(HW_REG_XCC_ID, 0, 4)
    s_and_b32 s54, s2, 7
    s_lshl_b32 s54, s54, 8
    s_lshr_b32 s55, s2, 3
    s_lshl_b32 s55, s55, 3
    s_add_u32 s54, s54, s55
    s_add_u32 s54, s54, 4096
    v_mov_b32 v4, s53
    s_mov_b64 exec, 1
    buffer_store_dwordx2 v[4:5], v9, s[40:43], s54 offen sc1
    s_mov_b64 exec, -1
    s_barrier
    ds_read2_b32 v[16:17], v51 offset0:0 offset1:160
    ds_read2_b32 v[18:19], v53 offset0:0 offset1:160
    ds_read2_b32 v[20:21], v52 offset0:0 offset1:160
    ds_read2_b32 v[22:23], v54 offset0:0 offset1:160
    s_cmp_lt_u32 s44, 128
    s_waitcnt lgkmcnt(0)
    v_pk_add_f32 v[16:17], v[16:17], v[18:19]
    v_pk_add_f32 v[20:21], v[20:21], v[22:23]
    v_add_f32 v4, v16, v17
    v_add_f32 v6, v20, v21
    s_cbranch_scc1 L_Cq
    s_cmp_lt_u32 s44, 224
    s_cbranch_scc0 L_Cs
    buffer_store_dwordx4 v[4:7], v10, s[40:43], s50 offen sc1
    s_branch L_Cfin
L_Cs:
    v_add_f32 v4, v4, v6
    s_lshl_b32 s51, s99, 3
    s_add_u32 s50, s50, s51
    buffer_store_dwordx2 v[4:5], v10, s[40:43], s50 offen sc1
    s_branch L_Cfin
L_Cq:
    v_add_f32 v4, v4, v6
    buffer_store_dwordx2 v[4:5], v9, s[40:43], s52 offen sc1
    s_lshr_b32 s54, s44, 3
    s_add_u32 s54, s54, 0
    s_and_b32 s53, s44, 7
    s_lshl_b32 s53, s53, 4
    s_add_u32 s53, s53, s54
    s_lshl_b32 s53, s53, 13
    s_add_u32 s53, s53, 524288
    s_add_u32 s56, s53, 0x1000
    s_bfe_u32 s55, s44, 0x20001
    s_lshl_b32 s55, s55, 4
    s_add_u32 s55, s55, s54
    s_lshl_b32 s55, s55, 9
    s_and_b32 s54, s44, 1
    s_lshl_b32 s54, s54, 15
    s_add_u32 s55, s55, s54
    s_add_u32 s55, s55, 229376
    s_mov_b32 s54, 0x05040100
    s_mov_b32 s50, 0x07060302
    s_mov_b32 s51, 0x07060100
    v_lshlrev_b32 v182, 4, v0
    v_mov_b32 v183, s46
    s_barrier
    buffer_load_dwordx4 v[128:131], v182, s[40:43], s53 offen offset:0 sc1
    buffer_load_dwordx4 v[132:135], v182, s[40:43], s53 offen offset:1024 sc1
    buffer_load_dwordx4 v[136:139], v182, s[40:43], s53 offen offset:2048 sc1
    buffer_load_dwordx4 v[140:143], v182, s[40:43], s53 offen offset:3072 sc1
    buffer_load_dwordx4 v[144:147], v182, s[40:43], s56 offen offset:0 sc1
    buffer_load_dwordx4 v[148:151], v182, s[40:43], s56 offen offset:1024 sc1
    buffer_load_dwordx4 v[152:155], v182, s[40:43], s56 offen offset:2048 sc1
    buffer_load_dwordx4 v[156:159], v182, s[40:43], s56 offen offset:3072 sc1
    s_barrier
    s_branch L_Cc1
L_Cc0:
    s_add_u32 s96, s96, 1
    s_cmp_gt_u32 s96, 0x20000
    s_cbranch_scc1 L_fin
    s_cmp_gt_u32 s96, 24
    s_cselect_b32 s95, 2097152, 0
    s_xor_b32 s53, s53, s95
    s_xor_b32 s56, s56, s95
    s_sleep 2
L_Cc1:
    buffer_load_dwordx4 v[128:131], v182, s[40:43], s53 offen offset:0 sc1
    buffer_load_dwordx4 v[132:135], v182, s[40:43], s53 offen offset:1024 sc1
    buffer_load_dwordx4 v[136:139], v182, s[40:43], s53 offen offset:2048 sc1
    buffer_load_dwordx4 v[140:143], v182, s[40:43], s53 offen offset:3072 sc1
    buffer_load_dwordx4 v[144:147], v182, s[40:43], s56 offen offset:0 sc1
    buffer_load_dwordx4 v[148:151], v182, s[40:43], s56 offen offset:1024 sc1
    buffer_load_dwordx4 v[152:155], v182, s[40:43], s56 offen offset:2048 sc1
    buffer_load_dwordx4 v[156:159], v182, s[40:43], s56 offen offset:3072 sc1
    s_waitcnt vmcnt(0)
    v_bitop3_b32 v6, v129, v131, s46 bitop3:0x7e
    v_bitop3_b32 v6, v6, v133, s46 bitop3:0xf6
    v_bitop3_b32 v6, v6, v135, s46 bitop3:0xf6
    v_bitop3_b32 v6, v6, v137, s46 bitop3:0xf6
    v_bitop3_b32 v6, v6, v139, s46 bitop3:0xf6
    v_bitop3_b32 v6, v6, v141, s46 bitop3:0xf6
    v_bitop3_b32 v6, v6, v143, s46 bitop3:0xf6
    v_bitop3_b32 v6, v6, v145, s46 bitop3:0xf6
    v_bitop3_b32 v6, v6, v147, s46 bitop3:0xf6
    v_bitop3_b32 v6, v6, v149, s46 bitop3:0xf6
    v_bitop3_b32 v6, v6, v151, s46 bitop3:0xf6
    v_bitop3_b32 v6, v6, v153, s46 bitop3:0xf6
    v_bitop3_b32 v6, v6, v155, s46 bitop3:0xf6
    v_bitop3_b32 v6, v6, v157, s46 bitop3:0xf6
    v_bitop3_b32 v6, v6, v159, s46 bitop3:0xf6
    v_cmp_lt_u32 vcc, 0xffff, v6
    s_cbranch_vccnz L_Cc0
    s_setprio 3
    v_perm_b32 v160, v129, v131, s54
    v_perm_b32 v161, v133, v135, s54
    v_perm_b32 v162, v137, v139, s54
    v_perm_b32 v163, v141, v143, s54
    v_perm_b32 v164, v145, v147, s54
    v_perm_b32 v165, v149, v151, s54
    v_perm_b32 v166, v153, v155, s54
    v_perm_b32 v167, v157, v159, s54
    v_max3_f32 v7, v160, v161, v162
    v_max3_f32 v6, v163, v164, v165
    v_max3_f32 v7, v7, v166, v167
    v_max_f32 v7, v7, v6
    v_mov_b32 v6, v7
    s_nop 1
    v_permlane32_swap_b32 v7, v6
    v_max_f32 v171, v7, v6
    v_sub_f32 v160, v160, v171
    v_sub_f32 v161, v161, v171
    v_sub_f32 v162, v162, v171
    v_sub_f32 v163, v163, v171
    v_sub_f32 v164, v164, v171
    v_sub_f32 v165, v165, v171
    v_sub_f32 v166, v166, v171
    v_sub_f32 v167, v167, v171
    v_exp_f32 v160, v160
    v_exp_f32 v161, v161
    v_exp_f32 v162, v162
    v_exp_f32 v163, v163
    v_exp_f32 v164, v164
    v_exp_f32 v165, v165
    v_exp_f32 v166, v166
    v_exp_f32 v167, v167
    v_mul_f32 v168, v160, v128
    v_mul_f32 v169, v160, v130
    v_fmac_f32 v168, v161, v132
    v_fmac_f32 v169, v161, v134
    v_fmac_f32 v168, v162, v136
    v_fmac_f32 v169, v162, v138
    v_fmac_f32 v168, v163, v140
    v_fmac_f32 v169, v163, v142
    v_fmac_f32 v168, v164, v144
    v_fmac_f32 v169, v164, v146
    v_fmac_f32 v168, v165, v148
    v_fmac_f32 v169, v165, v150
    v_fmac_f32 v168, v166, v152
    v_fmac_f32 v169, v166, v154
    v_fmac_f32 v168, v167, v156
    v_fmac_f32 v169, v167, v158
    v_pk_add_f32 v[160:161], v[160:161], v[162:163]
    v_pk_add_f32 v[164:165], v[164:165], v[166:167]
    v_pk_add_f32 v[160:161], v[160:161], v[164:165]
    v_add_f32 v170, v160, v161
    v_mov_b32 v172, v168
    v_mov_b32 v173, v169
    v_mov_b32 v174, v170
    v_permlane32_swap_b32 v168, v172
    v_permlane32_swap_b32 v169, v173
    v_permlane32_swap_b32 v170, v174
    v_add_f32 v170, v170, v174
    v_pk_add_f32 v[168:169], v[168:169], v[172:173]
    v_rcp_f32 v174, v170
    v_log_f32 v170, v170
    v_mul_f32 v176, v168, v174
    v_add_f32 v170, v170, v171
    v_mul_f32 v178, v169, v174
    v_perm_b32 v177, v183, v170, s50
    v_perm_b32 v179, v183, v170, s51
    s_mov_b32 exec_hi, 0
    buffer_store_dwordx4 v[176:179], v182, s[40:43], s55 offen sc1
    s_mov_b64 exec, -1
    v_mov_b32 v7, s46
    s_barrier
L_Cfin:
    s_mov_b32 s52, 0xbfb8aa3b
    s_mov_b32 s96, 0
    s_barrier
    ds_read2st64_b32 v[16:17], v49 offset0:0 offset1:4
    ds_read2st64_b32 v[18:19], v50 offset0:0 offset1:4
    ds_read2st64_b32 v[20:21], v49 offset0:8 offset1:12
    ds_read2st64_b32 v[22:23], v50 offset0:8 offset1:12
    ds_read2st64_b32 v[24:25], v49 offset0:16 offset1:20
    ds_read2st64_b32 v[26:27], v50 offset0:16 offset1:20
    ds_read2st64_b32 v[28:29], v49 offset0:24 offset1:28
    ds_read2st64_b32 v[30:31], v50 offset0:24 offset1:28
    s_waitcnt lgkmcnt(4)
    v_pk_add_f32 v[16:17], v[16:17], v[18:19]
    v_pk_add_f32 v[20:21], v[20:21], v[22:23]
    v_pk_add_f32 v[16:17], v[16:17], v[20:21]
    s_waitcnt lgkmcnt(0)
    v_pk_add_f32 v[24:25], v[24:25], v[26:27]
    v_pk_add_f32 v[28:29], v[28:29], v[30:31]
    v_pk_add_f32 v[16:17], v[16:17], v[24:25]
    v_add_f32 v4, v16, v28
    v_add_f32 v6, v17, v29
    buffer_store_dwordx2 v[4:5], v9, s[40:43], s80 offen
    buffer_store_dwordx2 v[6:7], v9, s[40:43], s81 offen
L_Cf1:
    buffer_load_dwordx4 v[12:15], v48, s[40:43], s58 offen sc1
    s_waitcnt vmcnt(0)
    v_bitop3_b32 v16, v13, v15, s46 bitop3:0x7e
    v_cmp_ne_u32 vcc, 0, v16
    s_cbranch_vccnz L_Cf0
    v_permlane16_swap_b32 v12, v14
    v_add_f32 v12, v12, v14
    s_nop 1
    v_add_f32_dpp v12, v12, v12 row_ror:8 row_mask:0xf bank_mask:0xf
    s_nop 1
    v_add_f32_dpp v12, v12, v12 row_ror:4 row_mask:0xf bank_mask:0xf
    s_nop 1
    v_add_f32_dpp v12, v12, v12 row_ror:2 row_mask:0xf bank_mask:0xf
    v_cvt_pk_bf16_f32 v12, v12, v12
    v_lshlrev_b32 v12, 16, v12
    v_mul_f32 v13, s52, v12
    v_mov_b32 v14, v12
    v_exp_f32 v13, v13
    s_nop 0
    v_permlane32_swap_b32 v12, v14
    v_add_f32 v13, 1.0, v13
    v_rcp_f32 v13, v13
    s_nop 0
    v_mul_f32 v13, v13, v12
    v_cvt_pk_bf16_f32 v13, v13, v13
    v_lshlrev_b32 v13, 16, v13
    v_mul_f32 v13, v13, v14
    v_cvt_pk_bf16_f32 v13, v13, v13
    v_lshlrev_b32 v13, 16, v13
    v_add_f32 v13, v13, v3
    v_cvt_pk_bf16_f32 v13, v13, v13
    s_mov_b64 exec, 0x30003
    buffer_store_short v13, v2, s[36:39], s48 offen
    s_cmp_lg_u32 s44, 48
    s_cbranch_scc1 L_Cend
    s_mov_b64 exec, 1
    v_mov_b32 v4, 0
    buffer_store_dword v7, v4, s[40:43], 0 offen
L_Cend:
    s_endpgm
L_Cf0:
    s_add_u32 s96, s96, 1
    s_cmp_gt_u32 s96, 0x20000
    s_cbranch_scc1 L_fin
    s_cmp_gt_u32 s96, 24
    s_cselect_b32 s95, 2097152, 0
    s_xor_b32 s58, s58, s95
    s_branch L_Cf1
L_G:
    v_and_b32 v0, 63, v0
    v_lshrrev_b32 v4, 3, v0
    s_cmp_lt_u32 s2, 224
    s_cbranch_scc0 L_GS
    s_mov_b32 s51, s3
    s_mul_i32 s51, s51, 512
    s_add_u32 s51, s51, 74240
    v_lshl_add_u32 v60, v4, 6, s51
    buffer_load_dwordx4 v[136:139], v2, s[28:31], s48 offen nt
    s_addk_i32 s48, 7168
    s_mov_b32 s44, s2
    s_mov_b32 s96, 0
    s_mov_b32 s39, 0x20000
    s_mov_b32 s43, 0x20000
    s_mov_b32 s42, 4194304
    s_bfe_u32 s60, s2, 0x40003
    s_lshr_b32 s50, s2, 7
    s_lshl_b32 s51, s50, 2
    s_add_u32 s51, s51, s2
    s_and_b32 s51, s51, 7
    s_lshl_b32 s50, s50, 3
    s_add_u32 s61, s50, s51
    v_and_b32 v6, 1, v5
    v_cmp_eq_u32 vcc, 1, v6
    v_mov_b32 v6, 0x0c0c0100
    v_mov_b32 v7, 0x01000c0c
    v_cndmask_b32 v6, v6, v7, vcc
    v_lshrrev_b32 v1, 1, v5
    v_mov_b32 v16, 0x0c0c0c0c
    v_xor_b32 v7, v6, v16
    v_lshrrev_b32 v7, 2, v7
    v_and_b32 v7, 0x02020202, v7
    v_or_b32 v7, v7, v6
    v_cmp_eq_u32 vcc, 0, v1
    s_nop 1
    v_cndmask_b32 v8, v16, v6, vcc
    v_cndmask_b32 v12, v16, v7, vcc
    v_cmp_eq_u32 vcc, 1, v1
    s_nop 1
    v_cndmask_b32 v9, v16, v6, vcc
    v_cndmask_b32 v13, v16, v7, vcc
    v_cmp_eq_u32 vcc, 2, v1
    s_nop 1
    v_cndmask_b32 v10, v16, v6, vcc
    v_cndmask_b32 v14, v16, v7, vcc
    v_cmp_eq_u32 vcc, 3, v1
    s_nop 1
    v_cndmask_b32 v11, v16, v6, vcc
    v_cndmask_b32 v15, v16, v7, vcc
    s_waitcnt lgkmcnt(0)
    s_load_dword s47, s[26:27], 0
    s_mov_b64 s[40:41], s[26:27]
    s_mov_b64 s[36:37], s[20:21]
    s_mov_b32 s38, 7340032
    s_lshl_b32 s59, s60, 2
    s_add_u32 s59, s59, s3
    s_mul_i32 s49, s59, 114688
    s_add_u32 s52, s2, 4
    s_and_b32 s52, s52, 7
    s_lshl_b32 s52, s52, 7
    s_add_u32 s91, s49, s52
    s_add_u32 s91, s91, 1024
    s_and_b32 s52, s2, 7
    s_lshl_b32 s52, s52, 7
    s_add_u32 s49, s49, s52
    v_mul_u32_u24 v3, 14336, v4
    v_lshl_add_u32 v3, v5, 4, v3
    s_waitcnt vmcnt(2)
    buffer_load_dwordx4 v[140:143], v2, s[28:31], s48 offen nt
    s_addk_i32 s48, 7168
    s_waitcnt vmcnt(2)
    buffer_load_dwordx4 v[144:147], v2, s[28:31], s48 offen nt
    s_addk_i32 s48, 7168
    s_waitcnt vmcnt(2)
    buffer_load_dwordx4 v[148:151], v2, s[28:31], s48 offen nt
    s_addk_i32 s48, 7168
    s_barrier
    ds_read_b128 v[28:31], v60 offset:0
    ds_read_b128 v[32:35], v60 offset:16
    ds_read_b128 v[36:39], v60 offset:32
    ds_read_b128 v[40:43], v60 offset:48
    s_waitcnt lgkmcnt(0)
    s_add_u32 s46, s47, 0x9e3779b1
    v_perm_b32 v16, v28, v28, v8
    v_perm_b32 v17, v28, v28, v9
    v_perm_b32 v18, v28, v28, v10
    v_perm_b32 v19, v28, v28, v11
    v_perm_b32 v20, v28, v28, v12
    v_perm_b32 v21, v28, v28, v13
    v_perm_b32 v22, v28, v28, v14
    v_perm_b32 v23, v28, v28, v15
    v_mfma_f32_16x16x32_bf16 v[24:27], v[16:19], v[128:131], 0
    v_perm_b32 v16, v29, v29, v8
    v_perm_b32 v17, v29, v29, v9
    v_perm_b32 v18, v29, v29, v10
    v_perm_b32 v19, v29, v29, v11
    v_mfma_f32_16x16x32_bf16 v[24:27], v[20:23], v[132:135], v[24:27]
    v_perm_b32 v20, v29, v29, v12
    v_perm_b32 v21, v29, v29, v13
    v_perm_b32 v22, v29, v29, v14
    v_perm_b32 v23, v29, v29, v15
    v_mfma_f32_16x16x32_bf16 v[24:27], v[16:19], v[136:139], v[24:27]
    v_perm_b32 v16, v30, v30, v8
    v_perm_b32 v17, v30, v30, v9
    v_perm_b32 v18, v30, v30, v10
    v_perm_b32 v19, v30, v30, v11
    s_waitcnt vmcnt(2)
    v_mfma_f32_16x16x32_bf16 v[24:27], v[20:23], v[140:143], v[24:27]
    v_perm_b32 v20, v30, v30, v12
    v_perm_b32 v21, v30, v30, v13
    v_perm_b32 v22, v30, v30, v14
    v_perm_b32 v23, v30, v30, v15
    buffer_load_dwordx4 v[152:155], v2, s[28:31], s48 offen nt
    s_addk_i32 s48, 7168
    s_waitcnt vmcnt(2)
    v_mfma_f32_16x16x32_bf16 v[24:27], v[16:19], v[144:147], v[24:27]
    v_perm_b32 v16, v31, v31, v8
    v_perm_b32 v17, v31, v31, v9
    v_perm_b32 v18, v31, v31, v10
    v_perm_b32 v19, v31, v31, v11
    buffer_load_dwordx4 v[156:159], v2, s[28:31], s48 offen nt
    s_addk_i32 s48, 7168
    s_waitcnt vmcnt(2)
    v_mfma_f32_16x16x32_bf16 v[24:27], v[20:23], v[148:151], v[24:27]
    v_perm_b32 v20, v31, v31, v12
    v_perm_b32 v21, v31, v31, v13
    v_perm_b32 v22, v31, v31, v14
    v_perm_b32 v23, v31, v31, v15
    buffer_load_dwordx4 v[160:163], v2, s[28:31], s48 offen nt
    s_addk_i32 s48, 7168
    s_waitcnt vmcnt(2)
    v_mfma_f32_16x16x32_bf16 v[24:27], v[16:19], v[152:155], v[24:27]
    v_perm_b32 v16, v32, v32, v8
    v_perm_b32 v17, v32, v32, v9
    v_perm_b32 v18, v32, v32, v10
    v_perm_b32 v19, v32, v32, v11
    buffer_load_dwordx4 v[164:167], v2, s[28:31], s48 offen nt
    s_addk_i32 s48, 7168
    s_waitcnt vmcnt(2)
    v_mfma_f32_16x16x32_bf16 v[24:27], v[20:23], v[156:159], v[24:27]
    v_perm_b32 v20, v32, v32, v12
    v_perm_b32 v21, v32, v32, v13
    v_perm_b32 v22, v32, v32, v14
    v_perm_b32 v23, v32, v32, v15
    buffer_load_dwordx4 v[168:171], v2, s[28:31], s48 offen nt
    s_addk_i32 s48, 7168
    s_waitcnt vmcnt(2)
    v_mfma_f32_16x16x32_bf16 v[24:27], v[16:19], v[160:163], v[24:27]
    v_perm_b32 v16, v33, v33, v8
    v_perm_b32 v17, v33, v33, v9
    v_perm_b32 v18, v33, v33, v10
    v_perm_b32 v19, v33, v33, v11
    buffer_load_dwordx4 v[172:175], v2, s[28:31], s48 offen nt
    s_addk_i32 s48, 7168
    buffer_load_dwordx4 v[176:179], v2, s[28:31], s48 offen nt
    s_addk_i32 s48, 7168
    buffer_load_dwordx4 v[180:183], v2, s[28:31], s48 offen nt
    s_addk_i32 s48, 7168
    buffer_load_dwordx4 v[184:187], v2, s[28:31], s48 offen nt
    s_addk_i32 s48, 7168
    buffer_load_dwordx4 v[188:191], v2, s[28:31], s48 offen nt
    s_addk_i32 s48, 7168
    buffer_load_dwordx4 v[128:131], v2, s[28:31], s48 offen nt
    s_addk_i32 s48, 7168
    s_waitcnt vmcnt(7)
    v_mfma_f32_16x16x32_bf16 v[24:27], v[20:23], v[164:167], v[24:27]
    v_perm_b32 v20, v33, v33, v12
    v_perm_b32 v21, v33, v33, v13
    v_perm_b32 v22, v33, v33, v14
    v_perm_b32 v23, v33, v33, v15
    buffer_load_dwordx4 v[132:135], v2, s[28:31], s48 offen nt
    s_addk_i32 s48, 7168
    s_waitcnt vmcnt(7)
    v_mfma_f32_16x16x32_bf16 v[24:27], v[16:19], v[168:171], v[24:27]
    v_perm_b32 v16, v34, v34, v8
    v_perm_b32 v17, v34, v34, v9
    v_perm_b32 v18, v34, v34, v10
    v_perm_b32 v19, v34, v34, v11
    buffer_load_dwordx4 v[136:139], v2, s[28:31], s48 offen nt
    s_addk_i32 s48, 7168
    s_waitcnt vmcnt(7)
    v_mfma_f32_16x16x32_bf16 v[24:27], v[20:23], v[172:175], v[24:27]
    v_perm_b32 v20, v34, v34, v12
    v_perm_b32 v21, v34, v34, v13
    v_perm_b32 v22, v34, v34, v14
    v_perm_b32 v23, v34, v34, v15
    buffer_load_dwordx4 v[140:143], v2, s[28:31], s48 offen nt
    s_addk_i32 s48, 7168
    s_waitcnt vmcnt(7)
    v_mfma_f32_16x16x32_bf16 v[24:27], v[16:19], v[176:179], v[24:27]
    v_perm_b32 v16, v35, v35, v8
    v_perm_b32 v17, v35, v35, v9
    v_perm_b32 v18, v35, v35, v10
    v_perm_b32 v19, v35, v35, v11
    buffer_load_dwordx4 v[144:147], v2, s[28:31], s48 offen nt
    s_addk_i32 s48, 7168
    s_waitcnt vmcnt(7)
    v_mfma_f32_16x16x32_bf16 v[24:27], v[20:23], v[180:183], v[24:27]
    v_perm_b32 v20, v35, v35, v12
    v_perm_b32 v21, v35, v35, v13
    v_perm_b32 v22, v35, v35, v14
    v_perm_b32 v23, v35, v35, v15
    buffer_load_dwordx4 v[148:151], v2, s[28:31], s48 offen nt
    s_addk_i32 s48, 7168
    s_waitcnt vmcnt(7)
    v_mfma_f32_16x16x32_bf16 v[24:27], v[16:19], v[184:187], v[24:27]
    v_perm_b32 v16, v36, v36, v8
    v_perm_b32 v17, v36, v36, v9
    v_perm_b32 v18, v36, v36, v10
    v_perm_b32 v19, v36, v36, v11
    buffer_load_dwordx4 v[152:155], v2, s[28:31], s48 offen nt
    s_addk_i32 s48, 7168
    s_waitcnt vmcnt(7)
    v_mfma_f32_16x16x32_bf16 v[24:27], v[20:23], v[188:191], v[24:27]
    v_perm_b32 v20, v36, v36, v12
    v_perm_b32 v21, v36, v36, v13
    v_perm_b32 v22, v36, v36, v14
    v_perm_b32 v23, v36, v36, v15
    buffer_load_dwordx4 v[156:159], v2, s[28:31], s48 offen nt
    s_addk_i32 s48, 7168
    s_waitcnt vmcnt(7)
    v_mfma_f32_16x16x32_bf16 v[24:27], v[16:19], v[128:131], v[24:27]
    v_perm_b32 v16, v37, v37, v8
    v_perm_b32 v17, v37, v37, v9
    v_perm_b32 v18, v37, v37, v10
    v_perm_b32 v19, v37, v37, v11
    buffer_load_dwordx4 v[160:163], v2, s[28:31], s48 offen nt
    s_addk_i32 s48, 7168
    s_waitcnt vmcnt(7)
    v_mfma_f32_16x16x32_bf16 v[24:27], v[20:23], v[132:135], v[24:27]
    v_perm_b32 v20, v37, v37, v12
    v_perm_b32 v21, v37, v37, v13
    v_perm_b32 v22, v37, v37, v14
    v_perm_b32 v23, v37, v37, v15
    buffer_load_dwordx4 v[164:167], v2, s[28:31], s48 offen nt
    s_addk_i32 s48, 7168
    s_waitcnt vmcnt(7)
    v_mfma_f32_16x16x32_bf16 v[24:27], v[16:19], v[136:139], v[24:27]
    v_perm_b32 v16, v38, v38, v8
    v_perm_b32 v17, v38, v38, v9
    v_perm_b32 v18, v38, v38, v10
    v_perm_b32 v19, v38, v38, v11
    buffer_load_dwordx4 v[168:171], v2, s[28:31], s48 offen nt
    s_addk_i32 s48, 7168
    s_waitcnt vmcnt(7)
    v_mfma_f32_16x16x32_bf16 v[24:27], v[20:23], v[140:143], v[24:27]
    v_perm_b32 v20, v38, v38, v12
    v_perm_b32 v21, v38, v38, v13
    v_perm_b32 v22, v38, v38, v14
    v_perm_b32 v23, v38, v38, v15
    buffer_load_dwordx4 v[172:175], v2, s[28:31], s48 offen nt
    s_addk_i32 s48, 7168
    s_waitcnt vmcnt(7)
    v_mfma_f32_16x16x32_bf16 v[24:27], v[16:19], v[144:147], v[24:27]
    v_perm_b32 v16, v39, v39, v8
    v_perm_b32 v17, v39, v39, v9
    v_perm_b32 v18, v39, v39, v10
    v_perm_b32 v19, v39, v39, v11
    buffer_load_dwordx4 v[176:179], v2, s[28:31], s48 offen nt
    s_addk_i32 s48, 7168
    s_waitcnt vmcnt(7)
    v_mfma_f32_16x16x32_bf16 v[24:27], v[20:23], v[148:151], v[24:27]
    v_perm_b32 v20, v39, v39, v12
    v_perm_b32 v21, v39, v39, v13
    v_perm_b32 v22, v39, v39, v14
    v_perm_b32 v23, v39, v39, v15
    buffer_load_dwordx4 v[180:183], v2, s[28:31], s48 offen nt
    s_addk_i32 s48, 7168
    s_waitcnt vmcnt(7)
    v_mfma_f32_16x16x32_bf16 v[24:27], v[16:19], v[152:155], v[24:27]
    v_perm_b32 v16, v40, v40, v8
    v_perm_b32 v17, v40, v40, v9
    v_perm_b32 v18, v40, v40, v10
    v_perm_b32 v19, v40, v40, v11
    buffer_load_dwordx4 v[184:187], v2, s[28:31], s48 offen nt
    s_addk_i32 s48, 7168
    s_waitcnt vmcnt(7)
    v_mfma_f32_16x16x32_bf16 v[24:27], v[20:23], v[156:159], v[24:27]
    v_perm_b32 v20, v40, v40, v12
    v_perm_b32 v21, v40, v40, v13
    v_perm_b32 v22, v40, v40, v14
    v_perm_b32 v23, v40, v40, v15
    buffer_load_dwordx4 v[188:191], v2, s[28:31], s48 offen nt
    s_waitcnt vmcnt(7)
    v_mfma_f32_16x16x32_bf16 v[24:27], v[16:19], v[160:163], v[24:27]
    v_perm_b32 v16, v41, v41, v8
    v_perm_b32 v17, v41, v41, v9
    v_perm_b32 v18, v41, v41, v10
    v_perm_b32 v19, v41, v41, v11
    buffer_load_dwordx4 v[64:67], v3, s[36:39], s49 offen nt
    s_waitcnt vmcnt(7)
    v_mfma_f32_16x16x32_bf16 v[24:27], v[20:23], v[164:167], v[24:27]
    v_perm_b32 v20, v41, v41, v12
    v_perm_b32 v21, v41, v41, v13
    v_perm_b32 v22, v41, v41, v14
    v_perm_b32 v23, v41, v41, v15
    buffer_load_dwordx4 v[68:71], v3, s[36:39], s91 offen nt
    s_waitcnt vmcnt(7)
    v_mfma_f32_16x16x32_bf16 v[24:27], v[16:19], v[168:171], v[24:27]
    v_perm_b32 v16, v42, v42, v8
    v_perm_b32 v17, v42, v42, v9
    v_perm_b32 v18, v42, v42, v10
    v_perm_b32 v19, v42, v42, v11
    buffer_load_dwordx4 v[72:75], v3, s[36:39], s49 offen offset:2048 nt
    s_addk_i32 s49, 0x1000
    s_waitcnt vmcnt(7)
    v_mfma_f32_16x16x32_bf16 v[24:27], v[20:23], v[172:175], v[24:27]
    v_perm_b32 v20, v42, v42, v12
    v_perm_b32 v21, v42, v42, v13
    v_perm_b32 v22, v42, v42, v14
    v_perm_b32 v23, v42, v42, v15
    buffer_load_dwordx4 v[76:79], v3, s[36:39], s91 offen offset:2048 nt
    s_addk_i32 s91, 0x1000
    s_waitcnt vmcnt(7)
    v_mfma_f32_16x16x32_bf16 v[24:27], v[16:19], v[176:179], v[24:27]
    v_perm_b32 v16, v43, v43, v8
    v_perm_b32 v17, v43, v43, v9
    v_perm_b32 v18, v43, v43, v10
    v_perm_b32 v19, v43, v43, v11
    buffer_load_dwordx4 v[80:83], v3, s[36:39], s49 offen nt
    s_waitcnt vmcnt(7)
    v_mfma_f32_16x16x32_bf16 v[24:27], v[20:23], v[180:183], v[24:27]
    v_perm_b32 v20, v43, v43, v12
    v_perm_b32 v21, v43, v43, v13
    v_perm_b32 v22, v43, v43, v14
    v_perm_b32 v23, v43, v43, v15
    buffer_load_dwordx4 v[84:87], v3, s[36:39], s91 offen nt
    s_waitcnt vmcnt(7)
    v_mfma_f32_16x16x32_bf16 v[24:27], v[16:19], v[184:187], v[24:27]
    buffer_load_dwordx4 v[88:91], v3, s[36:39], s49 offen offset:2048 nt
    s_addk_i32 s49, 0x1000
    s_waitcnt vmcnt(7)
    v_mfma_f32_16x16x32_bf16 v[24:27], v[20:23], v[188:191], v[24:27]
    buffer_load_dwordx4 v[92:95], v3, s[36:39], s91 offen offset:2048 nt
    s_addk_i32 s91, 0x1000
    s_lshl_b32 s50, s3, 10
    s_add_u32 s50, s50, 65536
    v_lshl_add_u32 v6, v0, 4, s50
    s_nop 2
    ds_write_b128 v6, v[24:27]
    s_waitcnt lgkmcnt(0)
    s_barrier
    s_branch L_SECG
L_GS:
    s_lshl_b32 s51, s99, 2
    s_add_u32 s51, s51, s3
    s_mul_i32 s51, s51, 256
    s_add_u32 s51, s51, 74240
    v_lshl_add_u32 v60, v4, 5, s51
    s_mov_b32 s44, s2
    s_mov_b32 s96, 0
    s_mov_b32 s39, 0x20000
    s_mov_b32 s43, 0x20000
    s_mov_b32 s42, 4194304
    s_bfe_u32 s60, s2, 0x40003
    s_lshr_b32 s50, s2, 7
    s_lshl_b32 s51, s50, 2
    s_add_u32 s51, s51, s2
    s_and_b32 s51, s51, 7
    s_lshl_b32 s50, s50, 3
    s_add_u32 s61, s50, s51
    v_and_b32 v6, 1, v5
    v_cmp_eq_u32 vcc, 1, v6
    v_mov_b32 v6, 0x0c0c0100
    v_mov_b32 v7, 0x01000c0c
    v_cndmask_b32 v6, v6, v7, vcc
    v_lshrrev_b32 v1, 1, v5
    v_mov_b32 v16, 0x0c0c0c0c
    v_xor_b32 v7, v6, v16
    v_lshrrev_b32 v7, 2, v7
    v_and_b32 v7, 0x02020202, v7
    v_or_b32 v7, v7, v6
    v_cmp_eq_u32 vcc, 0, v1
    s_nop 1
    v_cndmask_b32 v8, v16, v6, vcc
    v_cndmask_b32 v12, v16, v7, vcc
    v_cmp_eq_u32 vcc, 1, v1
    s_nop 1
    v_cndmask_b32 v9, v16, v6, vcc
    v_cndmask_b32 v13, v16, v7, vcc
    v_cmp_eq_u32 vcc, 2, v1
    s_nop 1
    v_cndmask_b32 v10, v16, v6, vcc
    v_cndmask_b32 v14, v16, v7, vcc
    v_cmp_eq_u32 vcc, 3, v1
    s_nop 1
    v_cndmask_b32 v11, v16, v6, vcc
    v_cndmask_b32 v15, v16, v7, vcc
    s_waitcnt lgkmcnt(0)
    s_load_dword s47, s[26:27], 0
    s_mov_b64 s[40:41], s[26:27]
    s_mov_b64 s[36:37], s[20:21]
    s_mov_b32 s38, 7340032
    s_lshl_b32 s59, s60, 2
    s_add_u32 s59, s59, s3
    s_mul_i32 s49, s59, 114688
    s_add_u32 s52, s2, 4
    s_and_b32 s52, s52, 7
    s_lshl_b32 s52, s52, 7
    s_add_u32 s91, s49, s52
    s_add_u32 s91, s91, 1024
    s_and_b32 s52, s2, 7
    s_lshl_b32 s52, s52, 7
    s_add_u32 s49, s49, s52
    v_mul_u32_u24 v3, 14336, v4
    v_lshl_add_u32 v3, v5, 4, v3
    s_waitcnt vmcnt(1)
    buffer_load_dwordx4 v[136:139], v2, s[28:31], s48 offen nt
    s_addk_i32 s48, 7168
    s_waitcnt vmcnt(1)
    buffer_load_dwordx4 v[140:143], v2, s[28:31], s48 offen nt
    s_addk_i32 s48, 7168
    s_waitcnt vmcnt(1)
    buffer_load_dwordx4 v[144:147], v2, s[28:31], s48 offen nt
    s_addk_i32 s48, 7168
    s_barrier
    ds_read_b128 v[28:31], v60 offset:0
    ds_read_b128 v[32:35], v60 offset:16
    s_waitcnt lgkmcnt(0)
    s_add_u32 s46, s47, 0x9e3779b1
    v_perm_b32 v16, v28, v28, v8
    v_perm_b32 v17, v28, v28, v9
    v_perm_b32 v18, v28, v28, v10
    v_perm_b32 v19, v28, v28, v11
    v_perm_b32 v20, v28, v28, v12
    v_perm_b32 v21, v28, v28, v13
    v_perm_b32 v22, v28, v28, v14
    v_perm_b32 v23, v28, v28, v15
    v_mfma_f32_16x16x32_bf16 v[24:27], v[16:19], v[128:131], 0
    v_perm_b32 v16, v29, v29, v8
    v_perm_b32 v17, v29, v29, v9
    v_perm_b32 v18, v29, v29, v10
    v_perm_b32 v19, v29, v29, v11
    v_mfma_f32_16x16x32_bf16 v[24:27], v[20:23], v[132:135], v[24:27]
    v_perm_b32 v20, v29, v29, v12
    v_perm_b32 v21, v29, v29, v13
    v_perm_b32 v22, v29, v29, v14
    v_perm_b32 v23, v29, v29, v15
    v_mfma_f32_16x16x32_bf16 v[24:27], v[16:19], v[136:139], v[24:27]
    v_perm_b32 v16, v30, v30, v8
    v_perm_b32 v17, v30, v30, v9
    v_perm_b32 v18, v30, v30, v10
    v_perm_b32 v19, v30, v30, v11
    s_waitcnt vmcnt(1)
    v_mfma_f32_16x16x32_bf16 v[24:27], v[20:23], v[140:143], v[24:27]
    v_perm_b32 v20, v30, v30, v12
    v_perm_b32 v21, v30, v30, v13
    v_perm_b32 v22, v30, v30, v14
    v_perm_b32 v23, v30, v30, v15
    buffer_load_dwordx4 v[148:151], v2, s[28:31], s48 offen nt
    s_addk_i32 s48, 7168
    s_waitcnt vmcnt(1)
    v_mfma_f32_16x16x32_bf16 v[24:27], v[16:19], v[144:147], v[24:27]
    v_perm_b32 v16, v31, v31, v8
    v_perm_b32 v17, v31, v31, v9
    v_perm_b32 v18, v31, v31, v10
    v_perm_b32 v19, v31, v31, v11
    buffer_load_dwordx4 v[152:155], v2, s[28:31], s48 offen nt
    s_addk_i32 s48, 7168
    s_waitcnt vmcnt(1)
    v_mfma_f32_16x16x32_bf16 v[24:27], v[20:23], v[148:151], v[24:27]
    v_perm_b32 v20, v31, v31, v12
    v_perm_b32 v21, v31, v31, v13
    v_perm_b32 v22, v31, v31, v14
    v_perm_b32 v23, v31, v31, v15
    buffer_load_dwordx4 v[156:159], v2, s[28:31], s48 offen nt
    s_addk_i32 s48, 7168
    s_waitcnt vmcnt(1)
    v_mfma_f32_16x16x32_bf16 v[24:27], v[16:19], v[152:155], v[24:27]
    v_perm_b32 v16, v32, v32, v8
    v_perm_b32 v17, v32, v32, v9
    v_perm_b32 v18, v32, v32, v10
    v_perm_b32 v19, v32, v32, v11
    buffer_load_dwordx4 v[160:163], v2, s[28:31], s48 offen nt
    s_addk_i32 s48, 7168
    s_waitcnt vmcnt(1)
    v_mfma_f32_16x16x32_bf16 v[24:27], v[20:23], v[156:159], v[24:27]
    v_perm_b32 v20, v32, v32, v12
    v_perm_b32 v21, v32, v32, v13
    v_perm_b32 v22, v32, v32, v14
    v_perm_b32 v23, v32, v32, v15
    buffer_load_dwordx4 v[164:167], v2, s[28:31], s48 offen nt
    s_addk_i32 s48, 7168
    buffer_load_dwordx4 v[168:171], v2, s[28:31], s48 offen nt
    s_addk_i32 s48, 7168
    buffer_load_dwordx4 v[172:175], v2, s[28:31], s48 offen nt
    s_addk_i32 s48, 7168
    s_waitcnt vmcnt(3)
    v_mfma_f32_16x16x32_bf16 v[24:27], v[16:19], v[160:163], v[24:27]
    v_perm_b32 v16, v33, v33, v8
    v_perm_b32 v17, v33, v33, v9
    v_perm_b32 v18, v33, v33, v10
    v_perm_b32 v19, v33, v33, v11
    buffer_load_dwordx4 v[176:179], v2, s[28:31], s48 offen nt
    s_addk_i32 s48, 7168
    s_waitcnt vmcnt(3)
    v_mfma_f32_16x16x32_bf16 v[24:27], v[20:23], v[164:167], v[24:27]
    v_perm_b32 v20, v33, v33, v12
    v_perm_b32 v21, v33, v33, v13
    v_perm_b32 v22, v33, v33, v14
    v_perm_b32 v23, v33, v33, v15
    buffer_load_dwordx4 v[180:183], v2, s[28:31], s48 offen nt
    s_addk_i32 s48, 7168
    s_waitcnt vmcnt(3)
    v_mfma_f32_16x16x32_bf16 v[24:27], v[16:19], v[168:171], v[24:27]
    v_perm_b32 v16, v34, v34, v8
    v_perm_b32 v17, v34, v34, v9
    v_perm_b32 v18, v34, v34, v10
    v_perm_b32 v19, v34, v34, v11
    buffer_load_dwordx4 v[184:187], v2, s[28:31], s48 offen nt
    s_addk_i32 s48, 7168
    s_waitcnt vmcnt(3)
    v_mfma_f32_16x16x32_bf16 v[24:27], v[20:23], v[172:175], v[24:27]
    v_perm_b32 v20, v34, v34, v12
    v_perm_b32 v21, v34, v34, v13
    v_perm_b32 v22, v34, v34, v14
    v_perm_b32 v23, v34, v34, v15
    buffer_load_dwordx4 v[188:191], v2, s[28:31], s48 offen nt
    s_waitcnt vmcnt(3)
    v_mfma_f32_16x16x32_bf16 v[24:27], v[16:19], v[176:179], v[24:27]
    v_perm_b32 v16, v35, v35, v8
    v_perm_b32 v17, v35, v35, v9
    v_perm_b32 v18, v35, v35, v10
    v_perm_b32 v19, v35, v35, v11
    buffer_load_dwordx4 v[64:67], v3, s[36:39], s49 offen nt
    s_waitcnt vmcnt(3)
    v_mfma_f32_16x16x32_bf16 v[24:27], v[20:23], v[180:183], v[24:27]
    v_perm_b32 v20, v35, v35, v12
    v_perm_b32 v21, v35, v35, v13
    v_perm_b32 v22, v35, v35, v14
    v_perm_b32 v23, v35, v35, v15
    buffer_load_dwordx4 v[68:71], v3, s[36:39], s91 offen nt
    s_waitcnt vmcnt(3)
    v_mfma_f32_16x16x32_bf16 v[24:27], v[16:19], v[184:187], v[24:27]
    buffer_load_dwordx4 v[72:75], v3, s[36:39], s49 offen offset:2048 nt
    s_addk_i32 s49, 0x1000
    s_waitcnt vmcnt(3)
    v_mfma_f32_16x16x32_bf16 v[24:27], v[20:23], v[188:191], v[24:27]
    buffer_load_dwordx4 v[76:79], v3, s[36:39], s91 offen offset:2048 nt
    s_addk_i32 s91, 0x1000
    s_lshl_b32 s50, s3, 10
    s_add_u32 s50, s50, 65536
    v_lshl_add_u32 v6, v0, 4, s50
    s_nop 2
    ds_write_b128 v6, v[24:27]
    s_waitcnt lgkmcnt(0)
    s_barrier
    s_waitcnt vmcnt(3)
    buffer_load_dwordx4 v[80:83], v3, s[36:39], s49 offen nt
    s_waitcnt vmcnt(3)
    buffer_load_dwordx4 v[84:87], v3, s[36:39], s91 offen nt
    s_waitcnt vmcnt(3)
    buffer_load_dwordx4 v[88:91], v3, s[36:39], s49 offen offset:2048 nt
    s_addk_i32 s49, 0x1000
    s_waitcnt vmcnt(3)
    buffer_load_dwordx4 v[92:95], v3, s[36:39], s91 offen offset:2048 nt
    s_addk_i32 s91, 0x1000
    s_branch L_SECG
L_SECG:
    s_lshl_b32 s50, s3, 11
    s_add_u32 s50, s50, 81920
    v_lshl_add_u32 v61, v0, 4, s50
    s_mul_i32 s57, s59, 896
    s_add_u32 s58, s57, 163840
    s_add_u32 s57, s57, 98304
    v_min_u32 v60, 55, v0
    v_lshlrev_b32 v60, 4, v60
    v_mul_u32_u24 v63, 28, v4
    s_mov_b32 s50, 0x3d372713
    s_mov_b32 s51, 0xc0135761
    s_waitcnt vmcnt(7)
    buffer_load_dwordx4 v[96:99], v3, s[36:39], s49 offen nt
    s_waitcnt vmcnt(7)
    buffer_load_dwordx4 v[100:103], v3, s[36:39], s91 offen nt
    s_waitcnt vmcnt(7)
    buffer_load_dwordx4 v[104:107], v3, s[36:39], s49 offen offset:2048 nt
    s_addk_i32 s49, 0x1000
    s_waitcnt vmcnt(7)
    buffer_load_dwordx4 v[108:111], v3, s[36:39], s91 offen offset:2048 nt
    s_addk_i32 s91, 0x1000
    s_waitcnt vmcnt(7)
    buffer_load_dwordx4 v[112:115], v3, s[36:39], s49 offen nt
    s_waitcnt vmcnt(7)
    buffer_load_dwordx4 v[116:119], v3, s[36:39], s91 offen nt
    s_waitcnt vmcnt(3)
    s_and_b32 s92, s2, 7
    s_lshl_b32 s92, s92, 8
    s_add_u32 s92, s92, 4096
    v_and_b32 v56, 31, v0
    v_lshlrev_b32 v56, 3, v56
    buffer_load_dwordx2 v[56:57], v56, s[40:43], s92 offen sc1
    buffer_load_dwordx4 v[28:31], v60, s[40:43], s57 offen sc1
    buffer_load_dwordx4 v[32:35], v60, s[40:43], s58 offen sc1
    s_waitcnt vmcnt(0)
L_Gp1:
    v_bitop3_b32 v6, v29, v31, s46 bitop3:0x7e
    v_bitop3_b32 v6, v6, v33, s46 bitop3:0xf6
    v_bitop3_b32 v6, v6, v35, s46 bitop3:0xf6
    v_cmp_ne_u32 vcc, 0, v6
    s_cbranch_vccnz L_Gp0
L_Gp2:
    v_add_f32 v16, v28, v30
    v_add_f32 v17, v32, v34
    v_cvt_pk_bf16_f32 v17, v16, v17
    v_lshlrev_b32 v16, 16, v17
    v_and_b32 v17, 0xffff0000, v17
    v_mul_f32 v18, v16, v16
    v_fma_f32 v18, v18, s50, 1.0
    v_mul_f32 v18, v18, v16
    v_mul_f32 v18, s51, v18
    v_exp_f32 v18, v18
    s_nop 0
    v_add_f32 v18, 1.0, v18
    v_rcp_f32 v18, v18
    s_nop 0
    v_mul_f32 v18, v18, v16
    v_cvt_pk_bf16_f32 v18, v18, v18
    v_lshlrev_b32 v18, 16, v18
    v_mul_f32 v18, v18, v17
    v_cvt_pk_bf16_f32 v18, v18, v18
    ds_bpermute_b32 v36, v63, v18 offset:0
    ds_bpermute_b32 v37, v63, v18 offset:4
    ds_bpermute_b32 v38, v63, v18 offset:8
    ds_bpermute_b32 v39, v63, v18 offset:12
    ds_bpermute_b32 v40, v63, v18 offset:16
    ds_bpermute_b32 v41, v63, v18 offset:20
    ds_bpermute_b32 v42, v63, v18 offset:24
    s_waitcnt lgkmcnt(0)
    v_perm_b32 v16, v36, v36, v8
    v_perm_b32 v17, v36, v36, v9
    v_perm_b32 v18, v36, v36, v10
    v_perm_b32 v19, v36, v36, v11
    v_perm_b32 v20, v37, v37, v8
    v_perm_b32 v21, v37, v37, v9
    v_perm_b32 v22, v37, v37, v10
    v_perm_b32 v23, v37, v37, v11
    v_mfma_f32_16x16x32_bf16 v[24:27], v[16:19], v[64:67], 0
    v_mfma_f32_16x16x32_bf16 v[52:55], v[16:19], v[68:71], 0
    v_perm_b32 v16, v38, v38, v8
    v_perm_b32 v17, v38, v38, v9
    v_perm_b32 v18, v38, v38, v10
    v_perm_b32 v19, v38, v38, v11
    v_mfma_f32_16x16x32_bf16 v[24:27], v[20:23], v[72:75], v[24:27]
    v_mfma_f32_16x16x32_bf16 v[52:55], v[20:23], v[76:79], v[52:55]
    v_perm_b32 v20, v39, v39, v8
    v_perm_b32 v21, v39, v39, v9
    v_perm_b32 v22, v39, v39, v10
    v_perm_b32 v23, v39, v39, v11
    v_mfma_f32_16x16x32_bf16 v[24:27], v[16:19], v[80:83], v[24:27]
    v_mfma_f32_16x16x32_bf16 v[52:55], v[16:19], v[84:87], v[52:55]
    v_perm_b32 v16, v40, v40, v8
    v_perm_b32 v17, v40, v40, v9
    v_perm_b32 v18, v40, v40, v10
    v_perm_b32 v19, v40, v40, v11
    v_mfma_f32_16x16x32_bf16 v[24:27], v[20:23], v[88:91], v[24:27]
    v_mfma_f32_16x16x32_bf16 v[52:55], v[20:23], v[92:95], v[52:55]
    v_perm_b32 v20, v41, v41, v8
    v_perm_b32 v21, v41, v41, v9
    v_perm_b32 v22, v41, v41, v10
    v_perm_b32 v23, v41, v41, v11
    v_mfma_f32_16x16x32_bf16 v[24:27], v[16:19], v[96:99], v[24:27]
    v_mfma_f32_16x16x32_bf16 v[52:55], v[16:19], v[100:103], v[52:55]
    v_perm_b32 v16, v42, v42, v8
    v_perm_b32 v17, v42, v42, v9
    v_perm_b32 v18, v42, v42, v10
    v_perm_b32 v19, v42, v42, v11
    v_mfma_f32_16x16x32_bf16 v[24:27], v[20:23], v[104:107], v[24:27]
    v_mfma_f32_16x16x32_bf16 v[52:55], v[20:23], v[108:111], v[52:55]
    v_mfma_f32_16x16x32_bf16 v[24:27], v[16:19], v[112:115], v[24:27]
    v_mfma_f32_16x16x32_bf16 v[52:55], v[16:19], v[116:119], v[52:55]
    s_nop 6
    ds_write_b128 v61, v[24:27]
    ds_write_b128 v61, v[52:55] offset:1024
    s_waitcnt lgkmcnt(0)
    s_barrier
    s_getreg_b32 s92, hwreg(HW_REG_XCC_ID, 0, 4)
    v_xor_b32 v56, s92, v56
    v_bitop3_b32 v56, v56, v57, s46 bitop3:0xf6
    v_cmp_ne_u32 vcc, 0, v56
    s_nop 0
    s_or_b32 s93, vcc_lo, vcc_hi
L_glob:
    s_cmp_lg_u32 s3, 0
    s_cbranch_scc1 L_fin
    s_cmp_eq_u32 s93, 0
    s_cbranch_scc1 L_fin
    v_and_b32 v5, 3, v0
    v_bfe_u32 v6, v0, 2, 1
    v_lshl_add_u32 v6, v6, 4, v4
    v_lshlrev_b32 v6, 4, v6
    v_lshl_add_u32 v49, v5, 2, v6
    v_add_u32 v49, 81920, v49
    v_add_u32 v50, 640, v49
    v_lshlrev_b32 v9, 3, v0
    v_mov_b32 v5, s46
    v_mov_b32 v7, s46
    s_lshr_b32 s54, s2, 7
    s_lshl_b32 s54, s54, 17
    s_lshl_b32 s57, s60, 9
    s_add_u32 s54, s54, s57
    s_add_u32 s54, s54, 3670016
    s_and_b32 s57, s2, 7
    s_lshl_b32 s57, s57, 13
    s_add_u32 s57, s57, s54
    s_add_u32 s58, s2, 4
    s_and_b32 s58, s58, 7
    s_lshl_b32 s58, s58, 13
    s_add_u32 s58, s58, s54
    s_add_u32 s58, s58, 65536
    ds_read2st64_b32 v[16:17], v49 offset0:0 offset1:4
    ds_read2st64_b32 v[18:19], v50 offset0:0 offset1:4
    ds_read2st64_b32 v[20:21], v49 offset0:8 offset1:12
    ds_read2st64_b32 v[22:23], v50 offset0:8 offset1:12
    ds_read2st64_b32 v[24:25], v49 offset0:16 offset1:20
    ds_read2st64_b32 v[26:27], v50 offset0:16 offset1:20
    ds_read2st64_b32 v[28:29], v49 offset0:24 offset1:28
    ds_read2st64_b32 v[30:31], v50 offset0:24 offset1:28
    s_waitcnt lgkmcnt(4)
    v_pk_add_f32 v[16:17], v[16:17], v[18:19]
    v_pk_add_f32 v[20:21], v[20:21], v[22:23]
    v_pk_add_f32 v[16:17], v[16:17], v[20:21]
    s_waitcnt lgkmcnt(0)
    v_pk_add_f32 v[24:25], v[24:25], v[26:27]
    v_pk_add_f32 v[28:29], v[28:29], v[30:31]
    v_pk_add_f32 v[16:17], v[16:17], v[24:25]
    v_add_f32 v4, v16, v28
    v_add_f32 v6, v17, v29
    buffer_store_dwordx2 v[4:5], v9, s[40:43], s57 offen sc1
    buffer_store_dwordx2 v[6:7], v9, s[40:43], s58 offen sc1
    s_branch L_fin
L_Gp0:
    s_add_u32 s96, s96, 1
    s_cmp_gt_u32 s96, 0x20000
    s_cbranch_scc1 L_fin
    buffer_load_dwordx4 v[28:31], v60, s[40:43], s57 offen sc1
    buffer_load_dwordx4 v[32:35], v60, s[40:43], s58 offen sc1
    s_waitcnt vmcnt(0)
    s_branch L_Gp1
L_fin:
L_end:
    s_endpgm
.section .rodata,"a"
.p2align 6
.amdhsa_kernel recurrent_scan__sliding_block_cached__geglu_ffn__decode_kernel
  .amdhsa_next_free_vgpr 256
  .amdhsa_next_free_sgpr 102
  .amdhsa_accum_offset 256
  .amdhsa_group_segment_fixed_size 0
  .amdhsa_kernarg_size 96
  .amdhsa_user_sgpr_count 2
  .amdhsa_user_sgpr_kernarg_segment_ptr 1
  .amdhsa_system_sgpr_workgroup_id_x 1
.end_amdhsa_kernel
```
